```python
import torch

def _softmax(x, axis=-1):
    return torch.softmax(x, dim=axis)
def _gelu(x):
    return torch.nn.functional.gelu(x, approximate="tanh")
def _silu(x):
    return torch.nn.functional.silu(x)
def _sigmoid(x):
    return torch.sigmoid(x)
def _layernorm(x, axis=-1, eps=1e-5):
    m = x.mean(dim=axis, keepdim=True)
    v = x.var(dim=axis, keepdim=True, unbiased=False)
    return (x - m) / torch.sqrt(v + eps)
def _scatter_add(tgt, idx, src, axis=0):
    return tgt.clone().index_add_(axis, idx, src)
def _segment_sum(src, seg, n):
    out = torch.zeros((n,) + src.shape[1:], dtype=src.dtype)
    return out.index_add_(0, seg, src)
def _pad(x, pw):
    flat = tuple(v for pair in reversed(pw) for v in pair)
    return torch.nn.functional.pad(x, flat)

kernel_name = 'standalone__mha_softmax__near_ridge'

def setup_inputs():

    _w = (lambda a: (lambda t: t.to(torch.bfloat16) if t.is_floating_point() else t)(torch.as_tensor(a)))
    B, H, Sq, Sk, D = 8, 32, 192, 1024, 128
    return {
        "q": _w((lambda *s: torch.randn(*s, dtype=torch.bfloat16) * 0.8)(B, H, Sq, D)),
        "k": _w((lambda *s: torch.randn(*s, dtype=torch.bfloat16) * 0.8)(B, H, Sk, D)),
        "v": _w((lambda *s: torch.randn(*s, dtype=torch.bfloat16) * 0.05)(B, H, Sk, D)),
    }

def reference(q, k, v):
    scale = q.shape[-1] ** -0.5
    scores = torch.einsum("bhqd,bhkd->bhqk", q, k) * scale
    p = _softmax(scores, axis=-1)
    return torch.einsum("bhqk,bhkd->bhqd", p, v)
```

```asm
; @launch grid=(256,1,1) block=(256,1,1) lds=131072
.amdgcn_target "amdgcn-amd-amdhsa--gfx950"
.text
.globl standalone__mha_softmax__near_ridge_kernel
.p2align 12
.fill 832, 4, 0xbf800000
.p2align 8
.type standalone__mha_softmax__near_ridge_kernel,@function
standalone__mha_softmax__near_ridge_kernel:
    s_load_dwordx8 s[4:11], s[0:1], 0
    s_cmp_ge_u32 s2, 256
    s_cbranch_scc1 END
    s_getpc_b64 s[24:25]
PC0:
    s_mov_b32 s26, CODE_END-PC0
    s_mov_b32 s27, 0x20000
    v_lshlrev_b32 v204, 7, v0
    buffer_load_dword v235, v204, s[24:27], 0 offen
    v_lshrrev_b32 v204, 6, v0
    v_and_b32 v205, 15, v0
    v_readfirstlane_b32 s35, v204
    v_bfe_u32 v206, v0, 4, 2
    v_lshlrev_b32 v208, 1, v206
    v_xor_b32 v208, v208, v205
    v_lshlrev_b32 v208, 4, v208
    v_lshl_add_u32 v186, v206, 8, v208
    v_xor_b32 v187, 0x80, v186
    s_and_b32 s3, s2, 7
    s_lshl_b32 s3, s3, 5
    s_lshr_b32 s38, s2, 3
    s_add_u32 s3, s3, s38
    s_lshl_b32 s38, s3, 18
    s_mul_i32 s3, s3, 49152
    s_lshl_b32 s43, s35, 12
    s_mul_i32 s40, s35, 12288
    s_add_u32 s41, s40, 4096
    s_add_u32 s42, s40, 8192
    s_mov_b32 s14, 49152
    s_mov_b32 s15, 0x20000
    s_mov_b32 s18, 262144
    s_mov_b32 s19, 0x20000
    s_mov_b32 s22, 262144
    s_mov_b32 s23, 0x20000
    s_sub_u32 s28, s43, 16384
    s_sub_u32 s29, s43, 16384
    s_waitcnt lgkmcnt(0)
    s_add_u32 s16, s6, s38
    s_addc_u32 s17, s7, 0
    s_add_u32 m0, s43, 0
    s_add_u32 s28, s28, 16384
    buffer_load_dwordx4 v186, s[16:19], s28 offen offset:0 nt lds
    buffer_load_dwordx4 v187, s[16:19], s28 offen offset:1024 nt lds
    buffer_load_dwordx4 v186, s[16:19], s28 offen offset:2048 nt lds
    buffer_load_dwordx4 v187, s[16:19], s28 offen offset:3072 nt lds
    s_add_u32 s12, s4, s3
    s_addc_u32 s13, s5, 0
    s_add_u32 m0, s40, 81920
    s_nop 0
    buffer_load_dwordx4 v186, s[12:15], s40 offen offset:0 nt lds
    buffer_load_dwordx4 v187, s[12:15], s40 offen offset:1024 nt lds
    buffer_load_dwordx4 v186, s[12:15], s40 offen offset:2048 nt lds
    buffer_load_dwordx4 v187, s[12:15], s40 offen offset:3072 nt lds
    s_add_u32 s20, s8, s38
    s_addc_u32 s21, s9, 0
    s_add_u32 m0, s41, 81920
    s_nop 0
    buffer_load_dwordx4 v186, s[12:15], s41 offen offset:0 nt lds
    buffer_load_dwordx4 v187, s[12:15], s41 offen offset:1024 nt lds
    s_add_u32 s24, s10, s3
    s_addc_u32 s25, s11, 0
    s_mov_b32 s26, 49152
    s_mov_b32 s27, 0x20000
    v_and_b32 v208, 7, v205
    v_lshlrev_b32 v208, 1, v208
    v_xor_b32 v208, v208, v206
    v_lshlrev_b32 v208, 4, v208
    v_lshl_add_u32 v172, v205, 8, v208
    v_xor_b32 v173, 64, v172
    v_xor_b32 v174, 128, v172
    v_xor_b32 v175, 192, v172
    s_add_u32 s39, s40, 81920
    v_add_u32 v200, s39, v172
    v_add_u32 v201, s39, v173
    v_add_u32 v202, s39, v174
    v_add_u32 v203, s39, v175
    v_bfe_u32 v204, v0, 2, 4
    v_and_b32 v208, 7, v204
    v_lshlrev_b32 v208, 5, v208
    v_and_b32 v207, 3, v0
    v_lshl_add_u32 v208, v207, 3, v208
    v_lshl_add_u32 v208, v204, 8, v208
    v_add_u32 v176, 32768, v208
    v_xor_b32 v177, 32, v176
    v_xor_b32 v178, 64, v176
    v_xor_b32 v179, 96, v176
    v_xor_b32 v180, 128, v176
    v_xor_b32 v181, 160, v176
    v_xor_b32 v182, 192, v176
    v_xor_b32 v183, 224, v176
    v_lshrrev_b32 v208, 1, v206
    v_xor_b32 v208, v208, v205
    v_lshlrev_b32 v208, 4, v208
    v_lshl_add_u32 v208, v205, 8, v208
    v_and_b32 v207, 1, v206
    v_lshl_add_u32 v208, v207, 3, v208
    v_add_u32 v188, s39, v208
    v_xor_b32 v189, 32, v188
    v_xor_b32 v190, 64, v188
    v_xor_b32 v191, 96, v188
    v_xor_b32 v192, 128, v188
    v_xor_b32 v193, 160, v188
    v_xor_b32 v194, 192, v188
    v_xor_b32 v195, 224, v188
    v_xor_b32 v208, v206, v205
    v_lshlrev_b32 v208, 4, v208
    v_lshl_add_u32 v208, v206, 8, v208
    v_add_u32 v196, s39, v208
    v_xor_b32 v197, 1088, v196
    v_xor_b32 v198, 2176, v196
    v_xor_b32 v199, 3264, v196
    v_and_b32 v184, 63, v0
    v_lshlrev_b32 v184, 4, v184
    s_mov_b32 s30, 0x3e0293ee
    s_mov_b32 s31, 0x3e0293ee
    s_mov_b32 s34, 0x53800000
    v_mov_b32 v208, 0x3f803f80
    v_accvgpr_write_b32 a176, v208
    v_accvgpr_write_b32 a177, v208
    v_accvgpr_write_b32 a178, v208
    v_accvgpr_write_b32 a179, v208
    s_mov_b64 exec, 0
    s_cmp_eq_u32 s35, 1
    s_cbranch_scc1 PAD1
    s_cmp_eq_u32 s35, 2
    s_cbranch_scc1 PAD2
    s_cmp_eq_u32 s35, 3
    s_cbranch_scc1 PAD3
TOUCH_RET:
    s_mov_b64 exec, -1
    s_waitcnt vmcnt(6)
    s_barrier
    s_add_u32 m0, s41, 81920
    s_nop 0
    buffer_load_dwordx4 v186, s[12:15], s41 offen offset:2048 nt lds
    buffer_load_dwordx4 v187, s[12:15], s41 offen offset:3072 nt lds
    s_add_u32 m0, s43, 32768
    s_add_u32 s29, s29, 16384
    buffer_load_dwordx4 v186, s[20:23], s29 offen offset:0 nt lds
    buffer_load_dwordx4 v187, s[20:23], s29 offen offset:1024 nt lds
    ds_read_b128 a[48:51], v172 offset:0
    ds_read_b128 a[52:55], v173 offset:0
    ds_read_b128 a[56:59], v174 offset:0
    ds_read_b128 a[60:63], v175 offset:0
    ds_read_b128 a[64:67], v172 offset:4096
    ds_read_b128 a[68:71], v173 offset:4096
    ds_read_b128 a[72:75], v174 offset:4096
    ds_read_b128 a[76:79], v175 offset:4096
    ds_read_b128 a[80:83], v172 offset:8192
    ds_read_b128 a[84:87], v173 offset:8192
    ds_read_b128 a[88:91], v174 offset:8192
    ds_read_b128 a[92:95], v175 offset:8192
    ds_read_b128 a[96:99], v172 offset:12288
    ds_read_b128 a[100:103], v173 offset:12288
    ds_read_b128 a[104:107], v174 offset:12288
    ds_read_b128 a[108:111], v175 offset:12288
    s_waitcnt vmcnt(6)
    s_add_u32 m0, s43, 32768
    s_nop 0
    buffer_load_dwordx4 v186, s[20:23], s29 offen offset:2048 nt lds
    buffer_load_dwordx4 v187, s[20:23], s29 offen offset:3072 nt lds
    s_add_u32 m0, s42, 81920
    s_nop 0
    buffer_load_dwordx4 v186, s[12:15], s42 offen offset:0 nt lds
    buffer_load_dwordx4 v187, s[12:15], s42 offen offset:1024 nt lds
    ds_read_b128 v[204:207], v200 offset:0
    ds_read_b128 v[208:211], v201 offset:0
    ds_read_b128 v[212:215], v202 offset:0
    ds_read_b128 v[216:219], v203 offset:0
    s_waitcnt lgkmcnt(3)
    v_lshlrev_b32 v220, 16, v204
    v_and_b32 v221, 0xffff0000, v204
    v_lshlrev_b32 v222, 16, v205
    v_and_b32 v223, 0xffff0000, v205
    v_lshlrev_b32 v224, 16, v206
    v_and_b32 v225, 0xffff0000, v206
    v_lshlrev_b32 v226, 16, v207
    v_and_b32 v227, 0xffff0000, v207
    v_pk_mul_f32 v[220:221], v[220:221], s[30:31]
    v_pk_mul_f32 v[222:223], v[222:223], s[30:31]
    v_pk_mul_f32 v[224:225], v[224:225], s[30:31]
    v_pk_mul_f32 v[226:227], v[226:227], s[30:31]
    v_cvt_pk_bf16_f32 v204, v220, v221
    v_cvt_pk_bf16_f32 v205, v222, v223
    v_cvt_pk_bf16_f32 v206, v224, v225
    v_cvt_pk_bf16_f32 v207, v226, v227
    v_accvgpr_write_b32 a0, v204
    v_accvgpr_write_b32 a1, v205
    v_accvgpr_write_b32 a2, v206
    v_accvgpr_write_b32 a3, v207
    s_waitcnt lgkmcnt(2)
    v_lshlrev_b32 v220, 16, v208
    v_and_b32 v221, 0xffff0000, v208
    v_lshlrev_b32 v222, 16, v209
    v_and_b32 v223, 0xffff0000, v209
    v_lshlrev_b32 v224, 16, v210
    v_and_b32 v225, 0xffff0000, v210
    v_lshlrev_b32 v226, 16, v211
    v_and_b32 v227, 0xffff0000, v211
    v_pk_mul_f32 v[220:221], v[220:221], s[30:31]
    v_pk_mul_f32 v[222:223], v[222:223], s[30:31]
    v_pk_mul_f32 v[224:225], v[224:225], s[30:31]
    v_pk_mul_f32 v[226:227], v[226:227], s[30:31]
    v_cvt_pk_bf16_f32 v208, v220, v221
    v_cvt_pk_bf16_f32 v209, v222, v223
    v_cvt_pk_bf16_f32 v210, v224, v225
    v_cvt_pk_bf16_f32 v211, v226, v227
    v_accvgpr_write_b32 a4, v208
    v_accvgpr_write_b32 a5, v209
    v_accvgpr_write_b32 a6, v210
    v_accvgpr_write_b32 a7, v211
    s_waitcnt lgkmcnt(1)
    v_lshlrev_b32 v220, 16, v212
    v_and_b32 v221, 0xffff0000, v212
    v_lshlrev_b32 v222, 16, v213
    v_and_b32 v223, 0xffff0000, v213
    v_lshlrev_b32 v224, 16, v214
    v_and_b32 v225, 0xffff0000, v214
    v_lshlrev_b32 v226, 16, v215
    v_and_b32 v227, 0xffff0000, v215
    v_pk_mul_f32 v[220:221], v[220:221], s[30:31]
    v_pk_mul_f32 v[222:223], v[222:223], s[30:31]
    v_pk_mul_f32 v[224:225], v[224:225], s[30:31]
    v_pk_mul_f32 v[226:227], v[226:227], s[30:31]
    v_cvt_pk_bf16_f32 v212, v220, v221
    v_cvt_pk_bf16_f32 v213, v222, v223
    v_cvt_pk_bf16_f32 v214, v224, v225
    v_cvt_pk_bf16_f32 v215, v226, v227
    v_accvgpr_write_b32 a8, v212
    v_accvgpr_write_b32 a9, v213
    v_accvgpr_write_b32 a10, v214
    v_accvgpr_write_b32 a11, v215
    s_waitcnt lgkmcnt(0)
    v_lshlrev_b32 v220, 16, v216
    v_and_b32 v221, 0xffff0000, v216
    v_lshlrev_b32 v222, 16, v217
    v_and_b32 v223, 0xffff0000, v217
    v_lshlrev_b32 v224, 16, v218
    v_and_b32 v225, 0xffff0000, v218
    v_lshlrev_b32 v226, 16, v219
    v_and_b32 v227, 0xffff0000, v219
    v_pk_mul_f32 v[220:221], v[220:221], s[30:31]
    v_pk_mul_f32 v[222:223], v[222:223], s[30:31]
    v_pk_mul_f32 v[224:225], v[224:225], s[30:31]
    v_pk_mul_f32 v[226:227], v[226:227], s[30:31]
    v_cvt_pk_bf16_f32 v216, v220, v221
    v_cvt_pk_bf16_f32 v217, v222, v223
    v_cvt_pk_bf16_f32 v218, v224, v225
    v_cvt_pk_bf16_f32 v219, v226, v227
    v_accvgpr_write_b32 a12, v216
    v_accvgpr_write_b32 a13, v217
    v_accvgpr_write_b32 a14, v218
    v_accvgpr_write_b32 a15, v219
    v_mfma_f32_16x16x32_bf16 v[112:115], a[48:51], a[0:3], 0
    v_mfma_f32_16x16x32_bf16 v[112:115], a[52:55], a[4:7], v[112:115]
    v_mfma_f32_16x16x32_bf16 v[112:115], a[56:59], a[8:11], v[112:115]
    v_mfma_f32_16x16x32_bf16 v[112:115], a[60:63], a[12:15], v[112:115]
    v_mfma_f32_16x16x32_bf16 v[116:119], a[64:67], a[0:3], 0
    v_mfma_f32_16x16x32_bf16 v[116:119], a[68:71], a[4:7], v[116:119]
    v_mfma_f32_16x16x32_bf16 v[116:119], a[72:75], a[8:11], v[116:119]
    v_mfma_f32_16x16x32_bf16 v[116:119], a[76:79], a[12:15], v[116:119]
    v_mfma_f32_16x16x32_bf16 v[120:123], a[80:83], a[0:3], 0
    v_mfma_f32_16x16x32_bf16 v[120:123], a[84:87], a[4:7], v[120:123]
    v_mfma_f32_16x16x32_bf16 v[120:123], a[88:91], a[8:11], v[120:123]
    v_mfma_f32_16x16x32_bf16 v[120:123], a[92:95], a[12:15], v[120:123]
    v_mfma_f32_16x16x32_bf16 v[124:127], a[96:99], a[0:3], 0
    v_mfma_f32_16x16x32_bf16 v[124:127], a[100:103], a[4:7], v[124:127]
    v_mfma_f32_16x16x32_bf16 v[124:127], a[104:107], a[8:11], v[124:127]
    v_mfma_f32_16x16x32_bf16 v[124:127], a[108:111], a[12:15], v[124:127]
    v_max_f32 v228, v112, v113
    v_max3_f32 v228, v114, v115, v228
    v_max3_f32 v228, v116, v117, v228
    v_max3_f32 v228, v118, v119, v228
    v_max3_f32 v228, v120, v121, v228
    v_max3_f32 v228, v122, v123, v228
    s_nop 1
    v_max3_f32 v228, v124, v125, v228
    v_max3_f32 v228, v126, v127, v228
    v_mov_b32 v229, v228
    s_nop 1
    v_permlane32_swap_b32 v228, v229
    v_max_f32 v228, v229, v228
    v_mov_b32 v229, v228
    s_nop 1
    v_permlane16_swap_b32 v228, v229
    v_max_f32 v228, v229, v228
    v_sub_f32 v112, v112, v228
    v_sub_f32 v113, v113, v228
    v_sub_f32 v114, v114, v228
    v_sub_f32 v115, v115, v228
    v_sub_f32 v116, v116, v228
    v_sub_f32 v117, v117, v228
    v_sub_f32 v118, v118, v228
    v_sub_f32 v119, v119, v228
    v_sub_f32 v120, v120, v228
    v_sub_f32 v121, v121, v228
    v_sub_f32 v122, v122, v228
    v_sub_f32 v123, v123, v228
    v_sub_f32 v124, v124, v228
    v_sub_f32 v125, v125, v228
    v_sub_f32 v126, v126, v228
    v_sub_f32 v127, v127, v228
    v_sub_f32 v160, 0, v228
    v_sub_f32 v161, 0, v228
    v_sub_f32 v162, 0, v228
    v_sub_f32 v163, 0, v228
    v_exp_f32 v112, v112
    v_exp_f32 v113, v113
    v_exp_f32 v114, v114
    v_cvt_pk_bf16_f32 v112, v112, v113
    v_exp_f32 v115, v115
    v_exp_f32 v116, v116
    v_cvt_pk_bf16_f32 v113, v114, v115
    v_exp_f32 v117, v117
    v_exp_f32 v118, v118
    v_cvt_pk_bf16_f32 v114, v116, v117
    v_exp_f32 v119, v119
    v_exp_f32 v120, v120
    v_cvt_pk_bf16_f32 v115, v118, v119
    v_exp_f32 v121, v121
    v_exp_f32 v122, v122
    v_cvt_pk_bf16_f32 v120, v120, v121
    v_exp_f32 v123, v123
    v_exp_f32 v124, v124
    v_cvt_pk_bf16_f32 v121, v122, v123
    v_exp_f32 v125, v125
    v_exp_f32 v126, v126
    v_cvt_pk_bf16_f32 v122, v124, v125
    v_exp_f32 v127, v127
    s_nop 0
    v_cvt_pk_bf16_f32 v123, v126, v127
    s_waitcnt vmcnt(6)
    s_add_u32 m0, s42, 81920
    s_nop 0
    buffer_load_dwordx4 v186, s[12:15], s42 offen offset:2048 nt lds
    buffer_load_dwordx4 v187, s[12:15], s42 offen offset:3072 nt lds
    s_add_u32 m0, s43, 16384
    s_add_u32 s28, s28, 16384
    buffer_load_dwordx4 v186, s[16:19], s28 offen offset:0 nt lds
    buffer_load_dwordx4 v187, s[16:19], s28 offen offset:1024 nt lds
    ds_read_b128 v[204:207], v200 offset:4096
    ds_read_b128 v[208:211], v201 offset:4096
    ds_read_b128 v[212:215], v202 offset:4096
    ds_read_b128 v[216:219], v203 offset:4096
    s_waitcnt lgkmcnt(3)
    v_lshlrev_b32 v220, 16, v204
    v_and_b32 v221, 0xffff0000, v204
    v_lshlrev_b32 v222, 16, v205
    v_and_b32 v223, 0xffff0000, v205
    v_lshlrev_b32 v224, 16, v206
    v_and_b32 v225, 0xffff0000, v206
    v_lshlrev_b32 v226, 16, v207
    v_and_b32 v227, 0xffff0000, v207
    v_pk_mul_f32 v[220:221], v[220:221], s[30:31]
    v_pk_mul_f32 v[222:223], v[222:223], s[30:31]
    v_pk_mul_f32 v[224:225], v[224:225], s[30:31]
    v_pk_mul_f32 v[226:227], v[226:227], s[30:31]
    v_cvt_pk_bf16_f32 v204, v220, v221
    v_cvt_pk_bf16_f32 v205, v222, v223
    v_cvt_pk_bf16_f32 v206, v224, v225
    v_cvt_pk_bf16_f32 v207, v226, v227
    v_accvgpr_write_b32 a16, v204
    v_accvgpr_write_b32 a17, v205
    v_accvgpr_write_b32 a18, v206
    v_accvgpr_write_b32 a19, v207
    s_waitcnt lgkmcnt(2)
    v_lshlrev_b32 v220, 16, v208
    v_and_b32 v221, 0xffff0000, v208
    v_lshlrev_b32 v222, 16, v209
    v_and_b32 v223, 0xffff0000, v209
    v_lshlrev_b32 v224, 16, v210
    v_and_b32 v225, 0xffff0000, v210
    v_lshlrev_b32 v226, 16, v211
    v_and_b32 v227, 0xffff0000, v211
    v_pk_mul_f32 v[220:221], v[220:221], s[30:31]
    v_pk_mul_f32 v[222:223], v[222:223], s[30:31]
    v_pk_mul_f32 v[224:225], v[224:225], s[30:31]
    v_pk_mul_f32 v[226:227], v[226:227], s[30:31]
    v_cvt_pk_bf16_f32 v208, v220, v221
    v_cvt_pk_bf16_f32 v209, v222, v223
    v_cvt_pk_bf16_f32 v210, v224, v225
    v_cvt_pk_bf16_f32 v211, v226, v227
    v_accvgpr_write_b32 a20, v208
    v_accvgpr_write_b32 a21, v209
    v_accvgpr_write_b32 a22, v210
    v_accvgpr_write_b32 a23, v211
    s_waitcnt lgkmcnt(1)
    v_lshlrev_b32 v220, 16, v212
    v_and_b32 v221, 0xffff0000, v212
    v_lshlrev_b32 v222, 16, v213
    v_and_b32 v223, 0xffff0000, v213
    v_lshlrev_b32 v224, 16, v214
    v_and_b32 v225, 0xffff0000, v214
    v_lshlrev_b32 v226, 16, v215
    v_and_b32 v227, 0xffff0000, v215
    v_pk_mul_f32 v[220:221], v[220:221], s[30:31]
    v_pk_mul_f32 v[222:223], v[222:223], s[30:31]
    v_pk_mul_f32 v[224:225], v[224:225], s[30:31]
    v_pk_mul_f32 v[226:227], v[226:227], s[30:31]
    v_cvt_pk_bf16_f32 v212, v220, v221
    v_cvt_pk_bf16_f32 v213, v222, v223
    v_cvt_pk_bf16_f32 v214, v224, v225
    v_cvt_pk_bf16_f32 v215, v226, v227
    v_accvgpr_write_b32 a24, v212
    v_accvgpr_write_b32 a25, v213
    v_accvgpr_write_b32 a26, v214
    v_accvgpr_write_b32 a27, v215
    s_waitcnt lgkmcnt(0)
    v_lshlrev_b32 v220, 16, v216
    v_and_b32 v221, 0xffff0000, v216
    v_lshlrev_b32 v222, 16, v217
    v_and_b32 v223, 0xffff0000, v217
    v_lshlrev_b32 v224, 16, v218
    v_and_b32 v225, 0xffff0000, v218
    v_lshlrev_b32 v226, 16, v219
    v_and_b32 v227, 0xffff0000, v219
    v_pk_mul_f32 v[220:221], v[220:221], s[30:31]
    v_pk_mul_f32 v[222:223], v[222:223], s[30:31]
    v_pk_mul_f32 v[224:225], v[224:225], s[30:31]
    v_pk_mul_f32 v[226:227], v[226:227], s[30:31]
    v_cvt_pk_bf16_f32 v216, v220, v221
    v_cvt_pk_bf16_f32 v217, v222, v223
    v_cvt_pk_bf16_f32 v218, v224, v225
    v_cvt_pk_bf16_f32 v219, v226, v227
    v_accvgpr_write_b32 a28, v216
    v_accvgpr_write_b32 a29, v217
    v_accvgpr_write_b32 a30, v218
    v_accvgpr_write_b32 a31, v219
    v_mfma_f32_16x16x32_bf16 v[128:131], a[48:51], a[16:19], 0
    v_mfma_f32_16x16x32_bf16 v[128:131], a[52:55], a[20:23], v[128:131]
    v_mfma_f32_16x16x32_bf16 v[128:131], a[56:59], a[24:27], v[128:131]
    v_mfma_f32_16x16x32_bf16 v[128:131], a[60:63], a[28:31], v[128:131]
    v_mfma_f32_16x16x32_bf16 v[132:135], a[64:67], a[16:19], 0
    v_mfma_f32_16x16x32_bf16 v[132:135], a[68:71], a[20:23], v[132:135]
    v_mfma_f32_16x16x32_bf16 v[132:135], a[72:75], a[24:27], v[132:135]
    v_mfma_f32_16x16x32_bf16 v[132:135], a[76:79], a[28:31], v[132:135]
    v_mfma_f32_16x16x32_bf16 v[136:139], a[80:83], a[16:19], 0
    v_mfma_f32_16x16x32_bf16 v[136:139], a[84:87], a[20:23], v[136:139]
    v_mfma_f32_16x16x32_bf16 v[136:139], a[88:91], a[24:27], v[136:139]
    v_mfma_f32_16x16x32_bf16 v[136:139], a[92:95], a[28:31], v[136:139]
    v_mfma_f32_16x16x32_bf16 v[140:143], a[96:99], a[16:19], 0
    v_mfma_f32_16x16x32_bf16 v[140:143], a[100:103], a[20:23], v[140:143]
    v_mfma_f32_16x16x32_bf16 v[140:143], a[104:107], a[24:27], v[140:143]
    v_mfma_f32_16x16x32_bf16 v[140:143], a[108:111], a[28:31], v[140:143]
    v_max_f32 v228, v128, v129
    v_max3_f32 v228, v130, v131, v228
    v_max3_f32 v228, v132, v133, v228
    v_max3_f32 v228, v134, v135, v228
    v_max3_f32 v228, v136, v137, v228
    v_max3_f32 v228, v138, v139, v228
    s_nop 1
    v_max3_f32 v228, v140, v141, v228
    v_max3_f32 v228, v142, v143, v228
    v_mov_b32 v229, v228
    s_nop 1
    v_permlane32_swap_b32 v228, v229
    v_max_f32 v228, v229, v228
    v_mov_b32 v229, v228
    s_nop 1
    v_permlane16_swap_b32 v228, v229
    v_max_f32 v228, v229, v228
    v_sub_f32 v128, v128, v228
    v_sub_f32 v129, v129, v228
    v_sub_f32 v130, v130, v228
    v_sub_f32 v131, v131, v228
    v_sub_f32 v132, v132, v228
    v_sub_f32 v133, v133, v228
    v_sub_f32 v134, v134, v228
    v_sub_f32 v135, v135, v228
    v_sub_f32 v136, v136, v228
    v_sub_f32 v137, v137, v228
    v_sub_f32 v138, v138, v228
    v_sub_f32 v139, v139, v228
    v_sub_f32 v140, v140, v228
    v_sub_f32 v141, v141, v228
    v_sub_f32 v142, v142, v228
    v_sub_f32 v143, v143, v228
    v_sub_f32 v164, 0, v228
    v_sub_f32 v165, 0, v228
    v_sub_f32 v166, 0, v228
    v_sub_f32 v167, 0, v228
    v_exp_f32 v128, v128
    v_exp_f32 v129, v129
    v_exp_f32 v130, v130
    v_cvt_pk_bf16_f32 v128, v128, v129
    v_exp_f32 v131, v131
    v_exp_f32 v132, v132
    v_cvt_pk_bf16_f32 v129, v130, v131
    v_exp_f32 v133, v133
    v_exp_f32 v134, v134
    v_cvt_pk_bf16_f32 v130, v132, v133
    v_exp_f32 v135, v135
    v_exp_f32 v136, v136
    v_cvt_pk_bf16_f32 v131, v134, v135
    v_exp_f32 v137, v137
    v_exp_f32 v138, v138
    v_cvt_pk_bf16_f32 v136, v136, v137
    v_exp_f32 v139, v139
    v_exp_f32 v140, v140
    v_cvt_pk_bf16_f32 v137, v138, v139
    v_exp_f32 v141, v141
    v_exp_f32 v142, v142
    v_cvt_pk_bf16_f32 v138, v140, v141
    v_exp_f32 v143, v143
    s_nop 0
    v_cvt_pk_bf16_f32 v139, v142, v143
    s_waitcnt vmcnt(6)
    s_barrier
    s_add_u32 m0, s43, 16384
    s_nop 0
    buffer_load_dwordx4 v186, s[16:19], s28 offen offset:2048 nt lds
    buffer_load_dwordx4 v187, s[16:19], s28 offen offset:3072 nt lds
    ds_read_b64_tr_b16 a[112:113], v176 offset:0
    ds_read_b64_tr_b16 a[114:115], v176 offset:4096
    ds_read_b64_tr_b16 a[116:117], v176 offset:8192
    ds_read_b64_tr_b16 a[118:119], v176 offset:12288
    ds_read_b64_tr_b16 a[120:121], v177 offset:0
    ds_read_b64_tr_b16 a[122:123], v177 offset:4096
    ds_read_b64_tr_b16 a[124:125], v177 offset:8192
    ds_read_b64_tr_b16 a[126:127], v177 offset:12288
    ds_read_b64_tr_b16 a[128:129], v178 offset:0
    ds_read_b64_tr_b16 a[130:131], v178 offset:4096
    ds_read_b64_tr_b16 a[132:133], v178 offset:8192
    ds_read_b64_tr_b16 a[134:135], v178 offset:12288
    ds_read_b64_tr_b16 a[136:137], v179 offset:0
    ds_read_b64_tr_b16 a[138:139], v179 offset:4096
    ds_read_b64_tr_b16 a[140:141], v179 offset:8192
    ds_read_b64_tr_b16 a[142:143], v179 offset:12288
    ds_read_b64_tr_b16 a[144:145], v180 offset:0
    ds_read_b64_tr_b16 a[146:147], v180 offset:4096
    ds_read_b64_tr_b16 a[148:149], v180 offset:8192
    ds_read_b64_tr_b16 a[150:151], v180 offset:12288
    ds_read_b64_tr_b16 a[152:153], v181 offset:0
    ds_read_b64_tr_b16 a[154:155], v181 offset:4096
    ds_read_b64_tr_b16 a[156:157], v181 offset:8192
    ds_read_b64_tr_b16 a[158:159], v181 offset:12288
    ds_read_b64_tr_b16 a[160:161], v182 offset:0
    ds_read_b64_tr_b16 a[162:163], v182 offset:4096
    ds_read_b64_tr_b16 a[164:165], v182 offset:8192
    ds_read_b64_tr_b16 a[166:167], v182 offset:12288
    ds_read_b64_tr_b16 a[168:169], v183 offset:0
    ds_read_b64_tr_b16 a[170:171], v183 offset:4096
    ds_read_b64_tr_b16 a[172:173], v183 offset:8192
    ds_read_b64_tr_b16 a[174:175], v183 offset:12288
    v_mfma_f32_16x16x32_bf16 v[100:103], a[176:179], v[112:115], 0
    v_mfma_f32_16x16x32_bf16 v[100:103], a[176:179], v[120:123], v[100:103]
    s_waitcnt lgkmcnt(15)
    v_mfma_f32_16x16x32_bf16 v[4:7], a[112:115], v[112:115], 0
    v_mfma_f32_16x16x32_bf16 v[4:7], a[116:119], v[120:123], v[4:7]
    v_mfma_f32_16x16x32_bf16 v[16:19], a[120:123], v[112:115], 0
    v_mfma_f32_16x16x32_bf16 v[16:19], a[124:127], v[120:123], v[16:19]
    v_mfma_f32_16x16x32_bf16 v[28:31], a[128:131], v[112:115], 0
    v_mfma_f32_16x16x32_bf16 v[28:31], a[132:135], v[120:123], v[28:31]
    v_mfma_f32_16x16x32_bf16 v[40:43], a[136:139], v[112:115], 0
    v_mfma_f32_16x16x32_bf16 v[40:43], a[140:143], v[120:123], v[40:43]
    s_waitcnt lgkmcnt(14)
    v_mfma_f32_16x16x32_bf16 v[52:55], a[144:147], v[112:115], 0
    s_waitcnt lgkmcnt(12)
    v_mfma_f32_16x16x32_bf16 v[52:55], a[148:151], v[120:123], v[52:55]
    s_waitcnt lgkmcnt(10)
    v_mfma_f32_16x16x32_bf16 v[64:67], a[152:155], v[112:115], 0
    s_waitcnt lgkmcnt(8)
    v_mfma_f32_16x16x32_bf16 v[64:67], a[156:159], v[120:123], v[64:67]
    s_waitcnt lgkmcnt(6)
    v_mfma_f32_16x16x32_bf16 v[76:79], a[160:163], v[112:115], 0
    s_waitcnt lgkmcnt(4)
    v_mfma_f32_16x16x32_bf16 v[76:79], a[164:167], v[120:123], v[76:79]
    s_waitcnt lgkmcnt(2)
    v_mfma_f32_16x16x32_bf16 v[88:91], a[168:171], v[112:115], 0
    s_waitcnt lgkmcnt(0)
    v_mfma_f32_16x16x32_bf16 v[88:91], a[172:175], v[120:123], v[88:91]
    v_mfma_f32_16x16x32_bf16 v[104:107], a[176:179], v[128:131], 0
    v_mfma_f32_16x16x32_bf16 v[104:107], a[176:179], v[136:139], v[104:107]
    v_mfma_f32_16x16x32_bf16 v[8:11], a[112:115], v[128:131], 0
    v_mfma_f32_16x16x32_bf16 v[8:11], a[116:119], v[136:139], v[8:11]
    v_mfma_f32_16x16x32_bf16 v[20:23], a[120:123], v[128:131], 0
    v_mfma_f32_16x16x32_bf16 v[20:23], a[124:127], v[136:139], v[20:23]
    v_mfma_f32_16x16x32_bf16 v[32:35], a[128:131], v[128:131], 0
    v_mfma_f32_16x16x32_bf16 v[32:35], a[132:135], v[136:139], v[32:35]
    v_mfma_f32_16x16x32_bf16 v[44:47], a[136:139], v[128:131], 0
    v_mfma_f32_16x16x32_bf16 v[44:47], a[140:143], v[136:139], v[44:47]
    v_mfma_f32_16x16x32_bf16 v[56:59], a[144:147], v[128:131], 0
    v_mfma_f32_16x16x32_bf16 v[56:59], a[148:151], v[136:139], v[56:59]
    v_mfma_f32_16x16x32_bf16 v[68:71], a[152:155], v[128:131], 0
    v_mfma_f32_16x16x32_bf16 v[68:71], a[156:159], v[136:139], v[68:71]
    v_mfma_f32_16x16x32_bf16 v[80:83], a[160:163], v[128:131], 0
    v_mfma_f32_16x16x32_bf16 v[80:83], a[164:167], v[136:139], v[80:83]
    v_mfma_f32_16x16x32_bf16 v[92:95], a[168:171], v[128:131], 0
    v_mfma_f32_16x16x32_bf16 v[92:95], a[172:175], v[136:139], v[92:95]
    s_waitcnt vmcnt(4)
    s_add_u32 m0, s43, 49152
    s_add_u32 s29, s29, 16384
    buffer_load_dwordx4 v186, s[20:23], s29 offen offset:0 nt lds
    buffer_load_dwordx4 v187, s[20:23], s29 offen offset:1024 nt lds
    ds_read_b128 v[204:207], v200 offset:8192
    ds_read_b128 v[208:211], v201 offset:8192
    ds_read_b128 v[212:215], v202 offset:8192
    ds_read_b128 v[216:219], v203 offset:8192
    s_waitcnt lgkmcnt(3)
    v_lshlrev_b32 v220, 16, v204
    v_and_b32 v221, 0xffff0000, v204
    v_lshlrev_b32 v222, 16, v205
    v_and_b32 v223, 0xffff0000, v205
    v_lshlrev_b32 v224, 16, v206
    v_and_b32 v225, 0xffff0000, v206
    v_lshlrev_b32 v226, 16, v207
    v_and_b32 v227, 0xffff0000, v207
    v_pk_mul_f32 v[220:221], v[220:221], s[30:31]
    v_pk_mul_f32 v[222:223], v[222:223], s[30:31]
    v_pk_mul_f32 v[224:225], v[224:225], s[30:31]
    v_pk_mul_f32 v[226:227], v[226:227], s[30:31]
    v_cvt_pk_bf16_f32 v204, v220, v221
    v_cvt_pk_bf16_f32 v205, v222, v223
    v_cvt_pk_bf16_f32 v206, v224, v225
    v_cvt_pk_bf16_f32 v207, v226, v227
    v_accvgpr_write_b32 a32, v204
    v_accvgpr_write_b32 a33, v205
    v_accvgpr_write_b32 a34, v206
    v_accvgpr_write_b32 a35, v207
    s_waitcnt lgkmcnt(2)
    v_lshlrev_b32 v220, 16, v208
    v_and_b32 v221, 0xffff0000, v208
    v_lshlrev_b32 v222, 16, v209
    v_and_b32 v223, 0xffff0000, v209
    v_lshlrev_b32 v224, 16, v210
    v_and_b32 v225, 0xffff0000, v210
    v_lshlrev_b32 v226, 16, v211
PAD1:
    s_cbranch_execz TOUCH_RET
    v_and_b32 v227, 0xffff0000, v211
    v_pk_mul_f32 v[220:221], v[220:221], s[30:31]
    v_pk_mul_f32 v[222:223], v[222:223], s[30:31]
    v_pk_mul_f32 v[224:225], v[224:225], s[30:31]
    v_pk_mul_f32 v[226:227], v[226:227], s[30:31]
    v_cvt_pk_bf16_f32 v208, v220, v221
    v_cvt_pk_bf16_f32 v209, v222, v223
    v_cvt_pk_bf16_f32 v210, v224, v225
    v_cvt_pk_bf16_f32 v211, v226, v227
    v_accvgpr_write_b32 a36, v208
    v_accvgpr_write_b32 a37, v209
    v_accvgpr_write_b32 a38, v210
    v_accvgpr_write_b32 a39, v211
    s_waitcnt lgkmcnt(1)
    v_lshlrev_b32 v220, 16, v212
    v_and_b32 v221, 0xffff0000, v212
    v_lshlrev_b32 v222, 16, v213
    v_and_b32 v223, 0xffff0000, v213
    v_lshlrev_b32 v224, 16, v214
    v_and_b32 v225, 0xffff0000, v214
    v_lshlrev_b32 v226, 16, v215
    v_and_b32 v227, 0xffff0000, v215
    v_pk_mul_f32 v[220:221], v[220:221], s[30:31]
    v_pk_mul_f32 v[222:223], v[222:223], s[30:31]
    v_pk_mul_f32 v[224:225], v[224:225], s[30:31]
    v_pk_mul_f32 v[226:227], v[226:227], s[30:31]
    v_cvt_pk_bf16_f32 v212, v220, v221
    v_cvt_pk_bf16_f32 v213, v222, v223
    v_cvt_pk_bf16_f32 v214, v224, v225
    v_cvt_pk_bf16_f32 v215, v226, v227
    v_accvgpr_write_b32 a40, v212
    v_accvgpr_write_b32 a41, v213
    v_accvgpr_write_b32 a42, v214
    v_accvgpr_write_b32 a43, v215
    s_waitcnt lgkmcnt(0)
    v_lshlrev_b32 v220, 16, v216
    v_and_b32 v221, 0xffff0000, v216
    v_lshlrev_b32 v222, 16, v217
    v_and_b32 v223, 0xffff0000, v217
    v_lshlrev_b32 v224, 16, v218
    v_and_b32 v225, 0xffff0000, v218
    v_lshlrev_b32 v226, 16, v219
    v_and_b32 v227, 0xffff0000, v219
    v_pk_mul_f32 v[220:221], v[220:221], s[30:31]
    v_pk_mul_f32 v[222:223], v[222:223], s[30:31]
    v_pk_mul_f32 v[224:225], v[224:225], s[30:31]
    v_pk_mul_f32 v[226:227], v[226:227], s[30:31]
    v_cvt_pk_bf16_f32 v216, v220, v221
    v_cvt_pk_bf16_f32 v217, v222, v223
    v_cvt_pk_bf16_f32 v218, v224, v225
    v_cvt_pk_bf16_f32 v219, v226, v227
    v_accvgpr_write_b32 a44, v216
    v_accvgpr_write_b32 a45, v217
    v_accvgpr_write_b32 a46, v218
    v_accvgpr_write_b32 a47, v219
    v_mfma_f32_16x16x32_bf16 v[144:147], a[48:51], a[32:35], 0
    v_mfma_f32_16x16x32_bf16 v[144:147], a[52:55], a[36:39], v[144:147]
    v_mfma_f32_16x16x32_bf16 v[144:147], a[56:59], a[40:43], v[144:147]
    v_mfma_f32_16x16x32_bf16 v[144:147], a[60:63], a[44:47], v[144:147]
    v_mfma_f32_16x16x32_bf16 v[148:151], a[64:67], a[32:35], 0
    v_mfma_f32_16x16x32_bf16 v[148:151], a[68:71], a[36:39], v[148:151]
    v_mfma_f32_16x16x32_bf16 v[148:151], a[72:75], a[40:43], v[148:151]
    v_mfma_f32_16x16x32_bf16 v[148:151], a[76:79], a[44:47], v[148:151]
    v_mfma_f32_16x16x32_bf16 v[152:155], a[80:83], a[32:35], 0
    v_mfma_f32_16x16x32_bf16 v[152:155], a[84:87], a[36:39], v[152:155]
    v_mfma_f32_16x16x32_bf16 v[152:155], a[88:91], a[40:43], v[152:155]
    v_mfma_f32_16x16x32_bf16 v[152:155], a[92:95], a[44:47], v[152:155]
    v_mfma_f32_16x16x32_bf16 v[156:159], a[96:99], a[32:35], 0
    v_mfma_f32_16x16x32_bf16 v[156:159], a[100:103], a[36:39], v[156:159]
    v_mfma_f32_16x16x32_bf16 v[156:159], a[104:107], a[40:43], v[156:159]
    v_mfma_f32_16x16x32_bf16 v[156:159], a[108:111], a[44:47], v[156:159]
    s_add_u32 m0, s43, 49152
    s_nop 0
    buffer_load_dwordx4 v186, s[20:23], s29 offen offset:2048 nt lds
    buffer_load_dwordx4 v187, s[20:23], s29 offen offset:3072 nt lds
    v_max_f32 v228, v144, v145
    v_max3_f32 v228, v146, v147, v228
    v_max3_f32 v228, v148, v149, v228
    v_max3_f32 v228, v150, v151, v228
    v_max3_f32 v228, v152, v153, v228
    v_max3_f32 v228, v154, v155, v228
    v_max3_f32 v228, v156, v157, v228
    v_max3_f32 v228, v158, v159, v228
    v_mov_b32 v229, v228
    s_nop 1
    v_permlane32_swap_b32 v228, v229
    v_max_f32 v228, v229, v228
    v_mov_b32 v229, v228
    s_nop 1
    v_permlane16_swap_b32 v228, v229
    v_max_f32 v228, v229, v228
    v_sub_f32 v144, v144, v228
    v_sub_f32 v145, v145, v228
    v_sub_f32 v146, v146, v228
    v_sub_f32 v147, v147, v228
    v_sub_f32 v148, v148, v228
    v_sub_f32 v149, v149, v228
    v_sub_f32 v150, v150, v228
    v_sub_f32 v151, v151, v228
    v_sub_f32 v152, v152, v228
    v_sub_f32 v153, v153, v228
    v_sub_f32 v154, v154, v228
    v_sub_f32 v155, v155, v228
    v_sub_f32 v156, v156, v228
    v_sub_f32 v157, v157, v228
    v_sub_f32 v158, v158, v228
    v_sub_f32 v159, v159, v228
    v_sub_f32 v168, 0, v228
    v_sub_f32 v169, 0, v228
    v_sub_f32 v170, 0, v228
    v_sub_f32 v171, 0, v228
    v_exp_f32 v144, v144
    v_exp_f32 v145, v145
    v_exp_f32 v146, v146
    v_cvt_pk_bf16_f32 v144, v144, v145
    v_exp_f32 v147, v147
    v_exp_f32 v148, v148
    v_cvt_pk_bf16_f32 v145, v146, v147
    v_exp_f32 v149, v149
    v_exp_f32 v150, v150
    v_cvt_pk_bf16_f32 v146, v148, v149
    v_exp_f32 v151, v151
    v_exp_f32 v152, v152
    v_cvt_pk_bf16_f32 v147, v150, v151
    v_exp_f32 v153, v153
    v_exp_f32 v154, v154
    v_cvt_pk_bf16_f32 v152, v152, v153
    v_exp_f32 v155, v155
    v_exp_f32 v156, v156
    v_cvt_pk_bf16_f32 v153, v154, v155
    v_exp_f32 v157, v157
    v_exp_f32 v158, v158
    v_cvt_pk_bf16_f32 v154, v156, v157
    v_exp_f32 v159, v159
    s_nop 0
    v_cvt_pk_bf16_f32 v155, v158, v159
    s_waitcnt vmcnt(4)
    s_barrier
    ds_read_b128 a[48:51], v172 offset:16384
    ds_read_b128 a[52:55], v173 offset:16384
    ds_read_b128 a[56:59], v174 offset:16384
    ds_read_b128 a[60:63], v175 offset:16384
    ds_read_b128 a[64:67], v172 offset:20480
    ds_read_b128 a[68:71], v173 offset:20480
    ds_read_b128 a[72:75], v174 offset:20480
    ds_read_b128 a[76:79], v175 offset:20480
    ds_read_b128 a[80:83], v172 offset:24576
    ds_read_b128 a[84:87], v173 offset:24576
    ds_read_b128 a[88:91], v174 offset:24576
    ds_read_b128 a[92:95], v175 offset:24576
    ds_read_b128 a[96:99], v172 offset:28672
    ds_read_b128 a[100:103], v173 offset:28672
    ds_read_b128 a[104:107], v174 offset:28672
    ds_read_b128 a[108:111], v175 offset:28672
    s_add_u32 m0, s43, 0
    s_add_u32 s28, s28, 16384
    buffer_load_dwordx4 v186, s[16:19], s28 offen offset:0 nt lds
    buffer_load_dwordx4 v187, s[16:19], s28 offen offset:1024 nt lds
    v_mfma_f32_16x16x32_bf16 v[108:111], a[176:179], v[144:147], 0
    v_mfma_f32_16x16x32_bf16 v[108:111], a[176:179], v[152:155], v[108:111]
    v_mfma_f32_16x16x32_bf16 v[12:15], a[112:115], v[144:147], 0
    v_mfma_f32_16x16x32_bf16 v[12:15], a[116:119], v[152:155], v[12:15]
    v_mfma_f32_16x16x32_bf16 v[24:27], a[120:123], v[144:147], 0
    v_mfma_f32_16x16x32_bf16 v[24:27], a[124:127], v[152:155], v[24:27]
    v_mfma_f32_16x16x32_bf16 v[36:39], a[128:131], v[144:147], 0
    v_mfma_f32_16x16x32_bf16 v[36:39], a[132:135], v[152:155], v[36:39]
    v_mfma_f32_16x16x32_bf16 v[48:51], a[136:139], v[144:147], 0
    v_mfma_f32_16x16x32_bf16 v[48:51], a[140:143], v[152:155], v[48:51]
    v_mfma_f32_16x16x32_bf16 v[60:63], a[144:147], v[144:147], 0
    v_mfma_f32_16x16x32_bf16 v[60:63], a[148:151], v[152:155], v[60:63]
    v_mfma_f32_16x16x32_bf16 v[72:75], a[152:155], v[144:147], 0
    v_mfma_f32_16x16x32_bf16 v[72:75], a[156:159], v[152:155], v[72:75]
    v_mfma_f32_16x16x32_bf16 v[84:87], a[160:163], v[144:147], 0
    v_mfma_f32_16x16x32_bf16 v[84:87], a[164:167], v[152:155], v[84:87]
    v_mfma_f32_16x16x32_bf16 v[96:99], a[168:171], v[144:147], 0
    v_mfma_f32_16x16x32_bf16 v[96:99], a[172:175], v[152:155], v[96:99]
    s_add_u32 m0, s43, 0
    s_nop 0
    buffer_load_dwordx4 v186, s[16:19], s28 offen offset:2048 nt lds
    buffer_load_dwordx4 v187, s[16:19], s28 offen offset:3072 nt lds
    s_waitcnt lgkmcnt(0)
    s_mov_b32 s32, 2
    s_mov_b32 s33, 0
    s_add_u32 s36, s43, 65536
    s_add_u32 s37, s43, 245760
LOOP0:
    s_waitcnt vmcnt(4) lgkmcnt(0)
    s_barrier
    ds_read_b64_tr_b16 a[112:113], v176 offset:16384
    ds_read_b64_tr_b16 a[114:115], v176 offset:20480
    v_mfma_f32_16x16x32_bf16 v[112:115], a[48:51], a[0:3], v[160:163]
    v_mfma_f32_16x16x32_bf16 v[112:115], a[52:55], a[4:7], v[112:115]
    v_mfma_f32_16x16x32_bf16 v[112:115], a[56:59], a[8:11], v[112:115]
    v_mfma_f32_16x16x32_bf16 v[112:115], a[60:63], a[12:15], v[112:115]
    ds_read_b64_tr_b16 a[116:117], v176 offset:24576
    ds_read_b64_tr_b16 a[118:119], v176 offset:28672
    ds_read_b64_tr_b16 a[120:121], v177 offset:16384
    v_mfma_f32_16x16x32_bf16 v[116:119], a[64:67], a[0:3], v[160:163]
    v_mfma_f32_16x16x32_bf16 v[116:119], a[68:71], a[4:7], v[116:119]
    v_mfma_f32_16x16x32_bf16 v[116:119], a[72:75], a[8:11], v[116:119]
    v_mfma_f32_16x16x32_bf16 v[116:119], a[76:79], a[12:15], v[116:119]
    ds_read_b64_tr_b16 a[122:123], v177 offset:20480
    ds_read_b64_tr_b16 a[124:125], v177 offset:24576
    ds_read_b64_tr_b16 a[126:127], v177 offset:28672
    v_mfma_f32_16x16x32_bf16 v[120:123], a[80:83], a[0:3], v[160:163]
    v_mfma_f32_16x16x32_bf16 v[120:123], a[84:87], a[4:7], v[120:123]
    v_mfma_f32_16x16x32_bf16 v[120:123], a[88:91], a[8:11], v[120:123]
    v_mfma_f32_16x16x32_bf16 v[120:123], a[92:95], a[12:15], v[120:123]
    ds_read_b64_tr_b16 a[128:129], v178 offset:16384
    ds_read_b64_tr_b16 a[130:131], v178 offset:20480
    ds_read_b64_tr_b16 a[132:133], v178 offset:24576
    v_exp_f32 v112, v112
    v_exp_f32 v113, v113
    v_exp_f32 v114, v114
    v_mfma_f32_16x16x32_bf16 v[124:127], a[96:99], a[0:3], v[160:163]
    v_exp_f32 v115, v115
    v_mfma_f32_16x16x32_bf16 v[124:127], a[100:103], a[4:7], v[124:127]
    v_mfma_f32_16x16x32_bf16 v[124:127], a[104:107], a[8:11], v[124:127]
    s_mov_b32 m0, s36
    v_mfma_f32_16x16x32_bf16 v[124:127], a[108:111], a[12:15], v[124:127]
    buffer_load_dwordx4 v186, s[20:23], s37 offen offset:0 nt lds
    ds_read_b64_tr_b16 a[134:135], v178 offset:28672
    ds_read_b64_tr_b16 a[136:137], v179 offset:16384
    ds_read_b64_tr_b16 a[138:139], v179 offset:20480
    v_cvt_pk_bf16_f32 v112, v112, v113
    v_cvt_pk_bf16_f32 v113, v114, v115
    v_exp_f32 v116, v116
    v_exp_f32 v117, v117
    v_exp_f32 v118, v118
    v_mfma_f32_16x16x32_bf16 v[128:131], a[48:51], a[16:19], v[164:167]
    v_exp_f32 v119, v119
    v_mfma_f32_16x16x32_bf16 v[128:131], a[52:55], a[20:23], v[128:131]
    v_mfma_f32_16x16x32_bf16 v[128:131], a[56:59], a[24:27], v[128:131]
    v_mfma_f32_16x16x32_bf16 v[128:131], a[60:63], a[28:31], v[128:131]
    ds_read_b64_tr_b16 a[140:141], v179 offset:24576
    ds_read_b64_tr_b16 a[142:143], v179 offset:28672
    ds_read_b64_tr_b16 a[144:145], v180 offset:16384
    v_cvt_pk_bf16_f32 v114, v116, v117
    v_cvt_pk_bf16_f32 v115, v118, v119
    v_exp_f32 v120, v120
    v_exp_f32 v121, v121
    v_exp_f32 v122, v122
    v_mfma_f32_16x16x32_bf16 v[132:135], a[64:67], a[16:19], v[164:167]
    v_exp_f32 v123, v123
    v_mfma_f32_16x16x32_bf16 v[132:135], a[68:71], a[20:23], v[132:135]
    v_mfma_f32_16x16x32_bf16 v[132:135], a[72:75], a[24:27], v[132:135]
    v_mfma_f32_16x16x32_bf16 v[132:135], a[76:79], a[28:31], v[132:135]
    ds_read_b64_tr_b16 a[146:147], v180 offset:20480
    ds_read_b64_tr_b16 a[148:149], v180 offset:24576
    ds_read_b64_tr_b16 a[150:151], v180 offset:28672
    v_cvt_pk_bf16_f32 v120, v120, v121
    v_cvt_pk_bf16_f32 v121, v122, v123
    v_exp_f32 v124, v124
    v_exp_f32 v125, v125
    v_exp_f32 v126, v126
    v_mfma_f32_16x16x32_bf16 v[136:139], a[80:83], a[16:19], v[164:167]
    v_exp_f32 v127, v127
    v_mfma_f32_16x16x32_bf16 v[136:139], a[84:87], a[20:23], v[136:139]
    v_mfma_f32_16x16x32_bf16 v[136:139], a[88:91], a[24:27], v[136:139]
    s_add_u32 m0, s43, 32768
    v_mfma_f32_16x16x32_bf16 v[136:139], a[92:95], a[28:31], v[136:139]
    s_add_u32 s29, s29, 16384
    buffer_load_dwordx4 v186, s[20:23], s29 offen offset:0 nt lds
    ds_read_b64_tr_b16 a[152:153], v181 offset:16384
    ds_read_b64_tr_b16 a[154:155], v181 offset:20480
    ds_read_b64_tr_b16 a[156:157], v181 offset:24576
    v_cvt_pk_bf16_f32 v122, v124, v125
    v_cvt_pk_bf16_f32 v123, v126, v127
    v_exp_f32 v128, v128
    v_exp_f32 v129, v129
    v_exp_f32 v130, v130
    v_mfma_f32_16x16x32_bf16 v[140:143], a[96:99], a[16:19], v[164:167]
    v_exp_f32 v131, v131
    v_mfma_f32_16x16x32_bf16 v[140:143], a[100:103], a[20:23], v[140:143]
    v_mfma_f32_16x16x32_bf16 v[140:143], a[104:107], a[24:27], v[140:143]
    v_mfma_f32_16x16x32_bf16 v[140:143], a[108:111], a[28:31], v[140:143]
    buffer_load_dwordx4 v187, s[20:23], s29 offen offset:1024 nt lds
    ds_read_b64_tr_b16 a[158:159], v181 offset:28672
    ds_read_b64_tr_b16 a[160:161], v182 offset:16384
    ds_read_b64_tr_b16 a[162:163], v182 offset:20480
    v_cvt_pk_bf16_f32 v128, v128, v129
    v_cvt_pk_bf16_f32 v129, v130, v131
    v_exp_f32 v132, v132
    v_exp_f32 v133, v133
    v_exp_f32 v134, v134
    v_mfma_f32_16x16x32_bf16 v[144:147], a[48:51], a[32:35], v[168:171]
    v_exp_f32 v135, v135
    v_mfma_f32_16x16x32_bf16 v[144:147], a[52:55], a[36:39], v[144:147]
    v_mfma_f32_16x16x32_bf16 v[144:147], a[56:59], a[40:43], v[144:147]
    v_mfma_f32_16x16x32_bf16 v[144:147], a[60:63], a[44:47], v[144:147]
    buffer_load_dwordx4 v186, s[20:23], s29 offen offset:2048 nt lds
    ds_read_b64_tr_b16 a[164:165], v182 offset:24576
    ds_read_b64_tr_b16 a[166:167], v182 offset:28672
    ds_read_b64_tr_b16 a[168:169], v183 offset:16384
    v_cvt_pk_bf16_f32 v130, v132, v133
    v_cvt_pk_bf16_f32 v131, v134, v135
    v_exp_f32 v136, v136
    v_exp_f32 v137, v137
    v_exp_f32 v138, v138
    v_mfma_f32_16x16x32_bf16 v[148:151], a[64:67], a[32:35], v[168:171]
    v_exp_f32 v139, v139
    v_mfma_f32_16x16x32_bf16 v[148:151], a[68:71], a[36:39], v[148:151]
    v_mfma_f32_16x16x32_bf16 v[148:151], a[72:75], a[40:43], v[148:151]
    v_mfma_f32_16x16x32_bf16 v[148:151], a[76:79], a[44:47], v[148:151]
    buffer_load_dwordx4 v187, s[20:23], s29 offen offset:3072 nt lds
    ds_read_b64_tr_b16 a[170:171], v183 offset:20480
    ds_read_b64_tr_b16 a[172:173], v183 offset:24576
    ds_read_b64_tr_b16 a[174:175], v183 offset:28672
    v_cvt_pk_bf16_f32 v136, v136, v137
    v_cvt_pk_bf16_f32 v137, v138, v139
    v_exp_f32 v140, v140
    v_exp_f32 v141, v141
    v_exp_f32 v142, v142
    v_mfma_f32_16x16x32_bf16 v[152:155], a[80:83], a[32:35], v[168:171]
    v_exp_f32 v143, v143
    v_mfma_f32_16x16x32_bf16 v[152:155], a[84:87], a[36:39], v[152:155]
    v_mfma_f32_16x16x32_bf16 v[152:155], a[88:91], a[40:43], v[152:155]
    v_mfma_f32_16x16x32_bf16 v[152:155], a[92:95], a[44:47], v[152:155]
    v_cvt_pk_bf16_f32 v138, v140, v141
    v_cvt_pk_bf16_f32 v139, v142, v143
    v_exp_f32 v144, v144
    v_exp_f32 v145, v145
    v_exp_f32 v146, v146
    v_mfma_f32_16x16x32_bf16 v[156:159], a[96:99], a[32:35], v[168:171]
    v_exp_f32 v147, v147
    v_mfma_f32_16x16x32_bf16 v[156:159], a[100:103], a[36:39], v[156:159]
    v_mfma_f32_16x16x32_bf16 v[156:159], a[104:107], a[40:43], v[156:159]
    v_mfma_f32_16x16x32_bf16 v[156:159], a[108:111], a[44:47], v[156:159]
    v_cvt_pk_bf16_f32 v144, v144, v145
    v_cvt_pk_bf16_f32 v145, v146, v147
    v_exp_f32 v148, v148
    v_exp_f32 v149, v149
    v_exp_f32 v150, v150
    v_mfma_f32_16x16x32_bf16 v[100:103], a[176:179], v[112:115], v[100:103]
    v_exp_f32 v151, v151
    v_mfma_f32_16x16x32_bf16 v[100:103], a[176:179], v[120:123], v[100:103]
    s_waitcnt lgkmcnt(0)
    v_mfma_f32_16x16x32_bf16 v[4:7], a[112:115], v[112:115], v[4:7]
    v_mfma_f32_16x16x32_bf16 v[4:7], a[116:119], v[120:123], v[4:7]
    v_cvt_pk_bf16_f32 v146, v148, v149
    v_cvt_pk_bf16_f32 v147, v150, v151
    v_exp_f32 v152, v152
    v_exp_f32 v153, v153
    v_exp_f32 v154, v154
    v_mfma_f32_16x16x32_bf16 v[16:19], a[120:123], v[112:115], v[16:19]
    v_exp_f32 v155, v155
    v_mfma_f32_16x16x32_bf16 v[16:19], a[124:127], v[120:123], v[16:19]
    v_mfma_f32_16x16x32_bf16 v[28:31], a[128:131], v[112:115], v[28:31]
    v_mfma_f32_16x16x32_bf16 v[28:31], a[132:135], v[120:123], v[28:31]
    v_cvt_pk_bf16_f32 v152, v152, v153
    v_cvt_pk_bf16_f32 v153, v154, v155
    v_exp_f32 v156, v156
    v_exp_f32 v157, v157
    v_exp_f32 v158, v158
    v_mfma_f32_16x16x32_bf16 v[40:43], a[136:139], v[112:115], v[40:43]
    v_exp_f32 v159, v159
    v_mfma_f32_16x16x32_bf16 v[40:43], a[140:143], v[120:123], v[40:43]
    v_mfma_f32_16x16x32_bf16 v[52:55], a[144:147], v[112:115], v[52:55]
    v_mfma_f32_16x16x32_bf16 v[52:55], a[148:151], v[120:123], v[52:55]
    v_cvt_pk_bf16_f32 v154, v156, v157
    v_cvt_pk_bf16_f32 v155, v158, v159
    v_mfma_f32_16x16x32_bf16 v[64:67], a[152:155], v[112:115], v[64:67]
    v_mfma_f32_16x16x32_bf16 v[64:67], a[156:159], v[120:123], v[64:67]
    v_mfma_f32_16x16x32_bf16 v[76:79], a[160:163], v[112:115], v[76:79]
    v_mfma_f32_16x16x32_bf16 v[76:79], a[164:167], v[120:123], v[76:79]
    v_mfma_f32_16x16x32_bf16 v[88:91], a[168:171], v[112:115], v[88:91]
    v_mfma_f32_16x16x32_bf16 v[88:91], a[172:175], v[120:123], v[88:91]
    v_mfma_f32_16x16x32_bf16 v[104:107], a[176:179], v[128:131], v[104:107]
    v_mfma_f32_16x16x32_bf16 v[104:107], a[176:179], v[136:139], v[104:107]
    v_mfma_f32_16x16x32_bf16 v[8:11], a[112:115], v[128:131], v[8:11]
    v_mfma_f32_16x16x32_bf16 v[8:11], a[116:119], v[136:139], v[8:11]
    v_mfma_f32_16x16x32_bf16 v[20:23], a[120:123], v[128:131], v[20:23]
    v_mfma_f32_16x16x32_bf16 v[20:23], a[124:127], v[136:139], v[20:23]
    v_mfma_f32_16x16x32_bf16 v[32:35], a[128:131], v[128:131], v[32:35]
    v_mfma_f32_16x16x32_bf16 v[32:35], a[132:135], v[136:139], v[32:35]
    v_mfma_f32_16x16x32_bf16 v[44:47], a[136:139], v[128:131], v[44:47]
    v_mfma_f32_16x16x32_bf16 v[44:47], a[140:143], v[136:139], v[44:47]
    v_mfma_f32_16x16x32_bf16 v[56:59], a[144:147], v[128:131], v[56:59]
    v_mfma_f32_16x16x32_bf16 v[56:59], a[148:151], v[136:139], v[56:59]
    v_mfma_f32_16x16x32_bf16 v[68:71], a[152:155], v[128:131], v[68:71]
    v_mfma_f32_16x16x32_bf16 v[68:71], a[156:159], v[136:139], v[68:71]
    v_mfma_f32_16x16x32_bf16 v[80:83], a[160:163], v[128:131], v[80:83]
    v_mfma_f32_16x16x32_bf16 v[80:83], a[164:167], v[136:139], v[80:83]
    s_waitcnt vmcnt(5)
    s_barrier
    ds_read_b128 a[48:51], v172 offset:0
    ds_read_b128 a[52:55], v173 offset:0
    v_mfma_f32_16x16x32_bf16 v[92:95], a[168:171], v[128:131], v[92:95]
    ds_read_b128 a[56:59], v174 offset:0
    v_mfma_f32_16x16x32_bf16 v[92:95], a[172:175], v[136:139], v[92:95]
    ds_read_b128 a[60:63], v175 offset:0
    v_mfma_f32_16x16x32_bf16 v[108:111], a[176:179], v[144:147], v[108:111]
    ds_read_b128 a[64:67], v172 offset:4096
    v_mfma_f32_16x16x32_bf16 v[108:111], a[176:179], v[152:155], v[108:111]
    ds_read_b128 a[68:71], v173 offset:4096
    v_mfma_f32_16x16x32_bf16 v[12:15], a[112:115], v[144:147], v[12:15]
    s_add_u32 m0, s43, 16384
    ds_read_b128 a[72:75], v174 offset:4096
    v_mfma_f32_16x16x32_bf16 v[12:15], a[116:119], v[152:155], v[12:15]
    s_add_u32 s28, s28, 16384
    buffer_load_dwordx4 v186, s[16:19], s28 offen offset:0 nt lds
    v_mfma_f32_16x16x32_bf16 v[24:27], a[120:123], v[144:147], v[24:27]
    ds_read_b128 a[76:79], v175 offset:4096
    v_mfma_f32_16x16x32_bf16 v[24:27], a[124:127], v[152:155], v[24:27]
    ds_read_b128 a[80:83], v172 offset:8192
    v_mfma_f32_16x16x32_bf16 v[36:39], a[128:131], v[144:147], v[36:39]
    ds_read_b128 a[84:87], v173 offset:8192
    v_mfma_f32_16x16x32_bf16 v[36:39], a[132:135], v[152:155], v[36:39]
    buffer_load_dwordx4 v187, s[16:19], s28 offen offset:1024 nt lds
    v_mfma_f32_16x16x32_bf16 v[48:51], a[136:139], v[144:147], v[48:51]
    ds_read_b128 a[88:91], v174 offset:8192
    v_mfma_f32_16x16x32_bf16 v[48:51], a[140:143], v[152:155], v[48:51]
    ds_read_b128 a[92:95], v175 offset:8192
    v_mfma_f32_16x16x32_bf16 v[60:63], a[144:147], v[144:147], v[60:63]
    ds_read_b128 a[96:99], v172 offset:12288
    v_mfma_f32_16x16x32_bf16 v[60:63], a[148:151], v[152:155], v[60:63]
    buffer_load_dwordx4 v186, s[16:19], s28 offen offset:2048 nt lds
    v_mfma_f32_16x16x32_bf16 v[72:75], a[152:155], v[144:147], v[72:75]
    ds_read_b128 a[100:103], v173 offset:12288
    v_mfma_f32_16x16x32_bf16 v[72:75], a[156:159], v[152:155], v[72:75]
    ds_read_b128 a[104:107], v174 offset:12288
    v_mfma_f32_16x16x32_bf16 v[84:87], a[160:163], v[144:147], v[84:87]
    ds_read_b128 a[108:111], v175 offset:12288
    v_mfma_f32_16x16x32_bf16 v[84:87], a[164:167], v[152:155], v[84:87]
    buffer_load_dwordx4 v187, s[16:19], s28 offen offset:3072 nt lds
    v_mfma_f32_16x16x32_bf16 v[96:99], a[168:171], v[144:147], v[96:99]
    v_mfma_f32_16x16x32_bf16 v[96:99], a[172:175], v[152:155], v[96:99]
    s_waitcnt vmcnt(4) lgkmcnt(0)
    s_barrier
    ds_read_b64_tr_b16 a[112:113], v176 offset:0
    ds_read_b64_tr_b16 a[114:115], v176 offset:4096
    v_mfma_f32_16x16x32_bf16 v[112:115], a[48:51], a[0:3], v[160:163]
    v_mfma_f32_16x16x32_bf16 v[112:115], a[52:55], a[4:7], v[112:115]
    v_mfma_f32_16x16x32_bf16 v[112:115], a[56:59], a[8:11], v[112:115]
    v_mfma_f32_16x16x32_bf16 v[112:115], a[60:63], a[12:15], v[112:115]
    ds_read_b64_tr_b16 a[116:117], v176 offset:8192
    ds_read_b64_tr_b16 a[118:119], v176 offset:12288
    ds_read_b64_tr_b16 a[120:121], v177 offset:0
    v_mfma_f32_16x16x32_bf16 v[116:119], a[64:67], a[0:3], v[160:163]
    v_mfma_f32_16x16x32_bf16 v[116:119], a[68:71], a[4:7], v[116:119]
    v_mfma_f32_16x16x32_bf16 v[116:119], a[72:75], a[8:11], v[116:119]
    v_mfma_f32_16x16x32_bf16 v[116:119], a[76:79], a[12:15], v[116:119]
    ds_read_b64_tr_b16 a[122:123], v177 offset:4096
    ds_read_b64_tr_b16 a[124:125], v177 offset:8192
    ds_read_b64_tr_b16 a[126:127], v177 offset:12288
    v_mfma_f32_16x16x32_bf16 v[120:123], a[80:83], a[0:3], v[160:163]
    v_mfma_f32_16x16x32_bf16 v[120:123], a[84:87], a[4:7], v[120:123]
    v_mfma_f32_16x16x32_bf16 v[120:123], a[88:91], a[8:11], v[120:123]
    v_mfma_f32_16x16x32_bf16 v[120:123], a[92:95], a[12:15], v[120:123]
    ds_read_b64_tr_b16 a[128:129], v178 offset:0
    ds_read_b64_tr_b16 a[130:131], v178 offset:4096
    ds_read_b64_tr_b16 a[132:133], v178 offset:8192
    v_exp_f32 v112, v112
    v_exp_f32 v113, v113
    v_exp_f32 v114, v114
    v_mfma_f32_16x16x32_bf16 v[124:127], a[96:99], a[0:3], v[160:163]
    v_exp_f32 v115, v115
    v_mfma_f32_16x16x32_bf16 v[124:127], a[100:103], a[4:7], v[124:127]
    v_mfma_f32_16x16x32_bf16 v[124:127], a[104:107], a[8:11], v[124:127]
    s_mov_b32 m0, s36
    v_mfma_f32_16x16x32_bf16 v[124:127], a[108:111], a[12:15], v[124:127]
    buffer_load_dwordx4 v187, s[20:23], s37 offen offset:1024 nt lds
    ds_read_b64_tr_b16 a[134:135], v178 offset:12288
    ds_read_b64_tr_b16 a[136:137], v179 offset:0
    ds_read_b64_tr_b16 a[138:139], v179 offset:4096
    v_cvt_pk_bf16_f32 v112, v112, v113
    v_cvt_pk_bf16_f32 v113, v114, v115
    v_exp_f32 v116, v116
    v_exp_f32 v117, v117
    v_exp_f32 v118, v118
    v_mfma_f32_16x16x32_bf16 v[128:131], a[48:51], a[16:19], v[164:167]
    s_add_u32 s36, s36, 2048
    v_exp_f32 v119, v119
    v_mfma_f32_16x16x32_bf16 v[128:131], a[52:55], a[20:23], v[128:131]
    s_add_u32 s37, s37, 2048
    v_mfma_f32_16x16x32_bf16 v[128:131], a[56:59], a[24:27], v[128:131]
    v_mfma_f32_16x16x32_bf16 v[128:131], a[60:63], a[28:31], v[128:131]
    ds_read_b64_tr_b16 a[140:141], v179 offset:8192
    ds_read_b64_tr_b16 a[142:143], v179 offset:12288
    ds_read_b64_tr_b16 a[144:145], v180 offset:0
    v_cvt_pk_bf16_f32 v114, v116, v117
    v_cvt_pk_bf16_f32 v115, v118, v119
    v_exp_f32 v120, v120
    v_exp_f32 v121, v121
    v_exp_f32 v122, v122
    v_mfma_f32_16x16x32_bf16 v[132:135], a[64:67], a[16:19], v[164:167]
    v_exp_f32 v123, v123
    v_mfma_f32_16x16x32_bf16 v[132:135], a[68:71], a[20:23], v[132:135]
    v_mfma_f32_16x16x32_bf16 v[132:135], a[72:75], a[24:27], v[132:135]
    v_mfma_f32_16x16x32_bf16 v[132:135], a[76:79], a[28:31], v[132:135]
    ds_read_b64_tr_b16 a[146:147], v180 offset:4096
    ds_read_b64_tr_b16 a[148:149], v180 offset:8192
    ds_read_b64_tr_b16 a[150:151], v180 offset:12288
    v_cvt_pk_bf16_f32 v120, v120, v121
    v_cvt_pk_bf16_f32 v121, v122, v123
    v_exp_f32 v124, v124
    v_exp_f32 v125, v125
    v_exp_f32 v126, v126
    v_mfma_f32_16x16x32_bf16 v[136:139], a[80:83], a[16:19], v[164:167]
    v_exp_f32 v127, v127
    v_mfma_f32_16x16x32_bf16 v[136:139], a[84:87], a[20:23], v[136:139]
    v_mfma_f32_16x16x32_bf16 v[136:139], a[88:91], a[24:27], v[136:139]
    s_add_u32 m0, s43, 49152
    v_mfma_f32_16x16x32_bf16 v[136:139], a[92:95], a[28:31], v[136:139]
    s_add_u32 s29, s29, 16384
    buffer_load_dwordx4 v186, s[20:23], s29 offen offset:0 nt lds
    ds_read_b64_tr_b16 a[152:153], v181 offset:0
    ds_read_b64_tr_b16 a[154:155], v181 offset:4096
    ds_read_b64_tr_b16 a[156:157], v181 offset:8192
    v_cvt_pk_bf16_f32 v122, v124, v125
    v_cvt_pk_bf16_f32 v123, v126, v127
    v_exp_f32 v128, v128
    v_exp_f32 v129, v129
    v_exp_f32 v130, v130
    v_mfma_f32_16x16x32_bf16 v[140:143], a[96:99], a[16:19], v[164:167]
    v_exp_f32 v131, v131
    v_mfma_f32_16x16x32_bf16 v[140:143], a[100:103], a[20:23], v[140:143]
    v_mfma_f32_16x16x32_bf16 v[140:143], a[104:107], a[24:27], v[140:143]
    v_mfma_f32_16x16x32_bf16 v[140:143], a[108:111], a[28:31], v[140:143]
    buffer_load_dwordx4 v187, s[20:23], s29 offen offset:1024 nt lds
    ds_read_b64_tr_b16 a[158:159], v181 offset:12288
    ds_read_b64_tr_b16 a[160:161], v182 offset:0
    ds_read_b64_tr_b16 a[162:163], v182 offset:4096
    v_cvt_pk_bf16_f32 v128, v128, v129
    v_cvt_pk_bf16_f32 v129, v130, v131
    v_exp_f32 v132, v132
    v_exp_f32 v133, v133
    v_exp_f32 v134, v134
    v_mfma_f32_16x16x32_bf16 v[144:147], a[48:51], a[32:35], v[168:171]
    v_exp_f32 v135, v135
    v_mfma_f32_16x16x32_bf16 v[144:147], a[52:55], a[36:39], v[144:147]
    v_mfma_f32_16x16x32_bf16 v[144:147], a[56:59], a[40:43], v[144:147]
    v_mfma_f32_16x16x32_bf16 v[144:147], a[60:63], a[44:47], v[144:147]
    buffer_load_dwordx4 v186, s[20:23], s29 offen offset:2048 nt lds
    ds_read_b64_tr_b16 a[164:165], v182 offset:8192
    ds_read_b64_tr_b16 a[166:167], v182 offset:12288
    ds_read_b64_tr_b16 a[168:169], v183 offset:0
    v_cvt_pk_bf16_f32 v130, v132, v133
    v_cvt_pk_bf16_f32 v131, v134, v135
    v_exp_f32 v136, v136
    v_exp_f32 v137, v137
    v_exp_f32 v138, v138
    v_mfma_f32_16x16x32_bf16 v[148:151], a[64:67], a[32:35], v[168:171]
    v_exp_f32 v139, v139
    v_mfma_f32_16x16x32_bf16 v[148:151], a[68:71], a[36:39], v[148:151]
    v_mfma_f32_16x16x32_bf16 v[148:151], a[72:75], a[40:43], v[148:151]
    v_mfma_f32_16x16x32_bf16 v[148:151], a[76:79], a[44:47], v[148:151]
    buffer_load_dwordx4 v187, s[20:23], s29 offen offset:3072 nt lds
    ds_read_b64_tr_b16 a[170:171], v183 offset:4096
    ds_read_b64_tr_b16 a[172:173], v183 offset:8192
    ds_read_b64_tr_b16 a[174:175], v183 offset:12288
    v_cvt_pk_bf16_f32 v136, v136, v137
    v_cvt_pk_bf16_f32 v137, v138, v139
    v_exp_f32 v140, v140
    v_exp_f32 v141, v141
    v_exp_f32 v142, v142
    v_mfma_f32_16x16x32_bf16 v[152:155], a[80:83], a[32:35], v[168:171]
    v_exp_f32 v143, v143
    v_mfma_f32_16x16x32_bf16 v[152:155], a[84:87], a[36:39], v[152:155]
    v_mfma_f32_16x16x32_bf16 v[152:155], a[88:91], a[40:43], v[152:155]
    v_mfma_f32_16x16x32_bf16 v[152:155], a[92:95], a[44:47], v[152:155]
    v_cvt_pk_bf16_f32 v138, v140, v141
    v_cvt_pk_bf16_f32 v139, v142, v143
    v_exp_f32 v144, v144
    v_exp_f32 v145, v145
    v_exp_f32 v146, v146
    v_mfma_f32_16x16x32_bf16 v[156:159], a[96:99], a[32:35], v[168:171]
    v_exp_f32 v147, v147
    v_mfma_f32_16x16x32_bf16 v[156:159], a[100:103], a[36:39], v[156:159]
    v_mfma_f32_16x16x32_bf16 v[156:159], a[104:107], a[40:43], v[156:159]
    v_mfma_f32_16x16x32_bf16 v[156:159], a[108:111], a[44:47], v[156:159]
    v_cvt_pk_bf16_f32 v144, v144, v145
    v_cvt_pk_bf16_f32 v145, v146, v147
    v_exp_f32 v148, v148
    v_exp_f32 v149, v149
    v_exp_f32 v150, v150
    v_mfma_f32_16x16x32_bf16 v[100:103], a[176:179], v[112:115], v[100:103]
    v_exp_f32 v151, v151
    v_mfma_f32_16x16x32_bf16 v[100:103], a[176:179], v[120:123], v[100:103]
    s_waitcnt lgkmcnt(0)
    v_mfma_f32_16x16x32_bf16 v[4:7], a[112:115], v[112:115], v[4:7]
    v_mfma_f32_16x16x32_bf16 v[4:7], a[116:119], v[120:123], v[4:7]
    v_cvt_pk_bf16_f32 v146, v148, v149
    v_cvt_pk_bf16_f32 v147, v150, v151
    v_exp_f32 v152, v152
    v_exp_f32 v153, v153
    v_exp_f32 v154, v154
    v_mfma_f32_16x16x32_bf16 v[16:19], a[120:123], v[112:115], v[16:19]
    v_exp_f32 v155, v155
    v_mfma_f32_16x16x32_bf16 v[16:19], a[124:127], v[120:123], v[16:19]
    v_mfma_f32_16x16x32_bf16 v[28:31], a[128:131], v[112:115], v[28:31]
    v_mfma_f32_16x16x32_bf16 v[28:31], a[132:135], v[120:123], v[28:31]
    v_cvt_pk_bf16_f32 v152, v152, v153
    v_cvt_pk_bf16_f32 v153, v154, v155
    v_exp_f32 v156, v156
    v_exp_f32 v157, v157
    v_exp_f32 v158, v158
    v_mfma_f32_16x16x32_bf16 v[40:43], a[136:139], v[112:115], v[40:43]
PAD2:
    s_cbranch_execz TOUCH_RET
    v_exp_f32 v159, v159
    v_mfma_f32_16x16x32_bf16 v[40:43], a[140:143], v[120:123], v[40:43]
    v_mfma_f32_16x16x32_bf16 v[52:55], a[144:147], v[112:115], v[52:55]
    v_mfma_f32_16x16x32_bf16 v[52:55], a[148:151], v[120:123], v[52:55]
    v_cvt_pk_bf16_f32 v154, v156, v157
    v_cvt_pk_bf16_f32 v155, v158, v159
    v_mfma_f32_16x16x32_bf16 v[64:67], a[152:155], v[112:115], v[64:67]
    v_mfma_f32_16x16x32_bf16 v[64:67], a[156:159], v[120:123], v[64:67]
    v_mfma_f32_16x16x32_bf16 v[76:79], a[160:163], v[112:115], v[76:79]
    v_mfma_f32_16x16x32_bf16 v[76:79], a[164:167], v[120:123], v[76:79]
    v_mfma_f32_16x16x32_bf16 v[88:91], a[168:171], v[112:115], v[88:91]
    v_mfma_f32_16x16x32_bf16 v[88:91], a[172:175], v[120:123], v[88:91]
    v_mfma_f32_16x16x32_bf16 v[104:107], a[176:179], v[128:131], v[104:107]
    v_mfma_f32_16x16x32_bf16 v[104:107], a[176:179], v[136:139], v[104:107]
    v_mfma_f32_16x16x32_bf16 v[8:11], a[112:115], v[128:131], v[8:11]
    v_mfma_f32_16x16x32_bf16 v[8:11], a[116:119], v[136:139], v[8:11]
    v_mfma_f32_16x16x32_bf16 v[20:23], a[120:123], v[128:131], v[20:23]
    v_mfma_f32_16x16x32_bf16 v[20:23], a[124:127], v[136:139], v[20:23]
    v_mfma_f32_16x16x32_bf16 v[32:35], a[128:131], v[128:131], v[32:35]
    v_mfma_f32_16x16x32_bf16 v[32:35], a[132:135], v[136:139], v[32:35]
    v_mfma_f32_16x16x32_bf16 v[44:47], a[136:139], v[128:131], v[44:47]
    v_mfma_f32_16x16x32_bf16 v[44:47], a[140:143], v[136:139], v[44:47]
    v_mfma_f32_16x16x32_bf16 v[56:59], a[144:147], v[128:131], v[56:59]
    v_mfma_f32_16x16x32_bf16 v[56:59], a[148:151], v[136:139], v[56:59]
    v_mfma_f32_16x16x32_bf16 v[68:71], a[152:155], v[128:131], v[68:71]
    v_mfma_f32_16x16x32_bf16 v[68:71], a[156:159], v[136:139], v[68:71]
    v_mfma_f32_16x16x32_bf16 v[80:83], a[160:163], v[128:131], v[80:83]
    v_mfma_f32_16x16x32_bf16 v[80:83], a[164:167], v[136:139], v[80:83]
    s_waitcnt vmcnt(5)
    s_barrier
    ds_read_b128 a[48:51], v172 offset:16384
    ds_read_b128 a[52:55], v173 offset:16384
    v_mfma_f32_16x16x32_bf16 v[92:95], a[168:171], v[128:131], v[92:95]
    ds_read_b128 a[56:59], v174 offset:16384
    v_mfma_f32_16x16x32_bf16 v[92:95], a[172:175], v[136:139], v[92:95]
    ds_read_b128 a[60:63], v175 offset:16384
    v_mfma_f32_16x16x32_bf16 v[108:111], a[176:179], v[144:147], v[108:111]
    ds_read_b128 a[64:67], v172 offset:20480
    v_mfma_f32_16x16x32_bf16 v[108:111], a[176:179], v[152:155], v[108:111]
    ds_read_b128 a[68:71], v173 offset:20480
    v_mfma_f32_16x16x32_bf16 v[12:15], a[112:115], v[144:147], v[12:15]
    s_add_u32 m0, s43, 0
    ds_read_b128 a[72:75], v174 offset:20480
    v_mfma_f32_16x16x32_bf16 v[12:15], a[116:119], v[152:155], v[12:15]
    s_add_u32 s28, s28, 16384
    buffer_load_dwordx4 v186, s[16:19], s28 offen offset:0 nt lds
    v_mfma_f32_16x16x32_bf16 v[24:27], a[120:123], v[144:147], v[24:27]
    ds_read_b128 a[76:79], v175 offset:20480
    v_mfma_f32_16x16x32_bf16 v[24:27], a[124:127], v[152:155], v[24:27]
    ds_read_b128 a[80:83], v172 offset:24576
    v_mfma_f32_16x16x32_bf16 v[36:39], a[128:131], v[144:147], v[36:39]
    ds_read_b128 a[84:87], v173 offset:24576
    v_mfma_f32_16x16x32_bf16 v[36:39], a[132:135], v[152:155], v[36:39]
    buffer_load_dwordx4 v187, s[16:19], s28 offen offset:1024 nt lds
    v_mfma_f32_16x16x32_bf16 v[48:51], a[136:139], v[144:147], v[48:51]
    ds_read_b128 a[88:91], v174 offset:24576
    v_mfma_f32_16x16x32_bf16 v[48:51], a[140:143], v[152:155], v[48:51]
    ds_read_b128 a[92:95], v175 offset:24576
    v_mfma_f32_16x16x32_bf16 v[60:63], a[144:147], v[144:147], v[60:63]
    ds_read_b128 a[96:99], v172 offset:28672
    v_mfma_f32_16x16x32_bf16 v[60:63], a[148:151], v[152:155], v[60:63]
    buffer_load_dwordx4 v186, s[16:19], s28 offen offset:2048 nt lds
    v_mfma_f32_16x16x32_bf16 v[72:75], a[152:155], v[144:147], v[72:75]
    ds_read_b128 a[100:103], v173 offset:28672
    v_mfma_f32_16x16x32_bf16 v[72:75], a[156:159], v[152:155], v[72:75]
    s_sub_u32 s32, s32, 1
    ds_read_b128 a[104:107], v174 offset:28672
    v_mfma_f32_16x16x32_bf16 v[84:87], a[160:163], v[144:147], v[84:87]
    ds_read_b128 a[108:111], v175 offset:28672
    v_mfma_f32_16x16x32_bf16 v[84:87], a[164:167], v[152:155], v[84:87]
    buffer_load_dwordx4 v187, s[16:19], s28 offen offset:3072 nt lds
    v_mfma_f32_16x16x32_bf16 v[96:99], a[168:171], v[144:147], v[96:99]
    s_cmp_lg_u32 s32, s33
    v_mfma_f32_16x16x32_bf16 v[96:99], a[172:175], v[152:155], v[96:99]
    s_cbranch_scc1 LOOP0
    s_mov_b32 s32, 5
    s_mov_b32 s33, 0
    s_mov_b32 s22, 245760
LOOP1:
    s_waitcnt vmcnt(4) lgkmcnt(0)
    s_barrier
    ds_read_b64_tr_b16 a[112:113], v176 offset:16384
    ds_read_b64_tr_b16 a[114:115], v176 offset:20480
    v_mfma_f32_16x16x32_bf16 v[112:115], a[48:51], a[0:3], v[160:163]
    ds_read_b64_tr_b16 a[116:117], v176 offset:24576
    v_mfma_f32_16x16x32_bf16 v[112:115], a[52:55], a[4:7], v[112:115]
    ds_read_b64_tr_b16 a[118:119], v176 offset:28672
    v_mfma_f32_16x16x32_bf16 v[112:115], a[56:59], a[8:11], v[112:115]
    ds_read_b64_tr_b16 a[120:121], v177 offset:16384
    v_mfma_f32_16x16x32_bf16 v[112:115], a[60:63], a[12:15], v[112:115]
    ds_read_b64_tr_b16 a[122:123], v177 offset:20480
    ds_read_b64_tr_b16 a[124:125], v177 offset:24576
    v_mfma_f32_16x16x32_bf16 v[116:119], a[64:67], a[0:3], v[160:163]
    ds_read_b64_tr_b16 a[126:127], v177 offset:28672
    v_mfma_f32_16x16x32_bf16 v[116:119], a[68:71], a[4:7], v[116:119]
    ds_read_b64_tr_b16 a[128:129], v178 offset:16384
    v_mfma_f32_16x16x32_bf16 v[116:119], a[72:75], a[8:11], v[116:119]
    ds_read_b64_tr_b16 a[130:131], v178 offset:20480
    v_mfma_f32_16x16x32_bf16 v[116:119], a[76:79], a[12:15], v[116:119]
    ds_read_b64_tr_b16 a[132:133], v178 offset:24576
    ds_read_b64_tr_b16 a[134:135], v178 offset:28672
    ds_read_b64_tr_b16 a[136:137], v179 offset:16384
    v_mfma_f32_16x16x32_bf16 v[120:123], a[80:83], a[0:3], v[160:163]
    v_exp_f32 v112, v112
    v_mfma_f32_16x16x32_bf16 v[120:123], a[84:87], a[4:7], v[120:123]
    v_exp_f32 v113, v113
    v_mfma_f32_16x16x32_bf16 v[120:123], a[88:91], a[8:11], v[120:123]
    v_exp_f32 v114, v114
    v_mfma_f32_16x16x32_bf16 v[120:123], a[92:95], a[12:15], v[120:123]
    ds_read_b64_tr_b16 a[138:139], v179 offset:20480
    ds_read_b64_tr_b16 a[140:141], v179 offset:24576
    ds_read_b64_tr_b16 a[142:143], v179 offset:28672
    v_mfma_f32_16x16x32_bf16 v[124:127], a[96:99], a[0:3], v[160:163]
    ds_read_b64_tr_b16 a[144:145], v180 offset:16384
    v_cvt_pk_bf16_f32 v112, v112, v113
    v_mfma_f32_16x16x32_bf16 v[124:127], a[100:103], a[4:7], v[124:127]
    v_exp_f32 v115, v115
    v_mfma_f32_16x16x32_bf16 v[124:127], a[104:107], a[8:11], v[124:127]
    v_exp_f32 v116, v116
    v_mfma_f32_16x16x32_bf16 v[124:127], a[108:111], a[12:15], v[124:127]
    ds_read_b64_tr_b16 a[146:147], v180 offset:20480
    ds_read_b64_tr_b16 a[148:149], v180 offset:24576
    v_mfma_f32_16x16x32_bf16 v[128:131], a[48:51], a[16:19], v[164:167]
    ds_read_b64_tr_b16 a[150:151], v180 offset:28672
    v_cvt_pk_bf16_f32 v113, v114, v115
    v_mfma_f32_16x16x32_bf16 v[128:131], a[52:55], a[20:23], v[128:131]
    v_exp_f32 v117, v117
    v_mfma_f32_16x16x32_bf16 v[128:131], a[56:59], a[24:27], v[128:131]
    v_exp_f32 v118, v118
    v_mfma_f32_16x16x32_bf16 v[128:131], a[60:63], a[28:31], v[128:131]
    ds_read_b64_tr_b16 a[152:153], v181 offset:16384
    ds_read_b64_tr_b16 a[154:155], v181 offset:20480
    v_mfma_f32_16x16x32_bf16 v[132:135], a[64:67], a[16:19], v[164:167]
    ds_read_b64_tr_b16 a[156:157], v181 offset:24576
    v_cvt_pk_bf16_f32 v114, v116, v117
    v_mfma_f32_16x16x32_bf16 v[132:135], a[68:71], a[20:23], v[132:135]
    v_exp_f32 v119, v119
    v_mfma_f32_16x16x32_bf16 v[132:135], a[72:75], a[24:27], v[132:135]
    v_exp_f32 v120, v120
    v_mfma_f32_16x16x32_bf16 v[132:135], a[76:79], a[28:31], v[132:135]
    ds_read_b64_tr_b16 a[158:159], v181 offset:28672
    ds_read_b64_tr_b16 a[160:161], v182 offset:16384
    v_mfma_f32_16x16x32_bf16 v[136:139], a[80:83], a[16:19], v[164:167]
    ds_read_b64_tr_b16 a[162:163], v182 offset:20480
    v_cvt_pk_bf16_f32 v115, v118, v119
    v_mfma_f32_16x16x32_bf16 v[136:139], a[84:87], a[20:23], v[136:139]
    v_exp_f32 v121, v121
    v_mfma_f32_16x16x32_bf16 v[136:139], a[88:91], a[24:27], v[136:139]
    s_add_u32 m0, s43, 32768
    v_exp_f32 v122, v122
    v_mfma_f32_16x16x32_bf16 v[136:139], a[92:95], a[28:31], v[136:139]
    s_add_u32 s29, s29, 16384
    buffer_load_dwordx4 v186, s[20:23], s29 offen offset:0 nt lds
    v_mfma_f32_16x16x32_bf16 v[140:143], a[96:99], a[16:19], v[164:167]
    ds_read_b64_tr_b16 a[164:165], v182 offset:24576
    v_cvt_pk_bf16_f32 v120, v120, v121
    v_mfma_f32_16x16x32_bf16 v[140:143], a[100:103], a[20:23], v[140:143]
    v_exp_f32 v123, v123
    v_mfma_f32_16x16x32_bf16 v[140:143], a[104:107], a[24:27], v[140:143]
    v_exp_f32 v124, v124
    v_mfma_f32_16x16x32_bf16 v[140:143], a[108:111], a[28:31], v[140:143]
    buffer_load_dwordx4 v187, s[20:23], s29 offen offset:1024 nt lds
    v_mfma_f32_16x16x32_bf16 v[144:147], a[48:51], a[32:35], v[168:171]
    ds_read_b64_tr_b16 a[166:167], v182 offset:28672
    v_cvt_pk_bf16_f32 v121, v122, v123
    v_mfma_f32_16x16x32_bf16 v[144:147], a[52:55], a[36:39], v[144:147]
    v_exp_f32 v125, v125
    v_mfma_f32_16x16x32_bf16 v[144:147], a[56:59], a[40:43], v[144:147]
    v_exp_f32 v126, v126
    v_mfma_f32_16x16x32_bf16 v[144:147], a[60:63], a[44:47], v[144:147]
    buffer_load_dwordx4 v186, s[20:23], s29 offen offset:2048 nt lds
    v_mfma_f32_16x16x32_bf16 v[148:151], a[64:67], a[32:35], v[168:171]
    ds_read_b64_tr_b16 a[168:169], v183 offset:16384
    v_cvt_pk_bf16_f32 v122, v124, v125
    v_mfma_f32_16x16x32_bf16 v[148:151], a[68:71], a[36:39], v[148:151]
    v_exp_f32 v127, v127
    v_mfma_f32_16x16x32_bf16 v[148:151], a[72:75], a[40:43], v[148:151]
    ds_read_b64_tr_b16 a[170:171], v183 offset:20480
    v_cvt_pk_bf16_f32 v123, v126, v127
    v_mfma_f32_16x16x32_bf16 v[148:151], a[76:79], a[44:47], v[148:151]
    buffer_load_dwordx4 v187, s[20:23], s29 offen offset:3072 nt lds
    v_mfma_f32_16x16x32_bf16 v[152:155], a[80:83], a[32:35], v[168:171]
    v_exp_f32 v128, v128
    v_mfma_f32_16x16x32_bf16 v[152:155], a[84:87], a[36:39], v[152:155]
    v_exp_f32 v129, v129
    v_mfma_f32_16x16x32_bf16 v[152:155], a[88:91], a[40:43], v[152:155]
    v_exp_f32 v130, v130
    v_mfma_f32_16x16x32_bf16 v[152:155], a[92:95], a[44:47], v[152:155]
    ds_read_b64_tr_b16 a[172:173], v183 offset:24576
    ds_read_b64_tr_b16 a[174:175], v183 offset:28672
    v_mfma_f32_16x16x32_bf16 v[156:159], a[96:99], a[32:35], v[168:171]
    v_exp_f32 v131, v131
    v_mfma_f32_16x16x32_bf16 v[156:159], a[100:103], a[36:39], v[156:159]
    v_exp_f32 v132, v132
    v_mfma_f32_16x16x32_bf16 v[156:159], a[104:107], a[40:43], v[156:159]
    v_exp_f32 v133, v133
    v_mfma_f32_16x16x32_bf16 v[156:159], a[108:111], a[44:47], v[156:159]
    v_exp_f32 v134, v134
    v_mfma_f32_16x16x32_bf16 v[100:103], a[176:179], v[112:115], v[100:103]
    v_exp_f32 v135, v135
    v_mfma_f32_16x16x32_bf16 v[100:103], a[176:179], v[120:123], v[100:103]
    s_waitcnt lgkmcnt(0)
    v_cvt_pk_bf16_f32 v128, v128, v129
    v_cvt_pk_bf16_f32 v129, v130, v131
    v_mfma_f32_16x16x32_bf16 v[4:7], a[112:115], v[112:115], v[4:7]
    v_exp_f32 v136, v136
    v_mfma_f32_16x16x32_bf16 v[4:7], a[116:119], v[120:123], v[4:7]
    v_exp_f32 v137, v137
    v_mfma_f32_16x16x32_bf16 v[16:19], a[120:123], v[112:115], v[16:19]
    v_exp_f32 v138, v138
    v_mfma_f32_16x16x32_bf16 v[16:19], a[124:127], v[120:123], v[16:19]
    v_cvt_pk_bf16_f32 v130, v132, v133
    v_cvt_pk_bf16_f32 v131, v134, v135
    v_mfma_f32_16x16x32_bf16 v[28:31], a[128:131], v[112:115], v[28:31]
    v_exp_f32 v139, v139
    v_mfma_f32_16x16x32_bf16 v[28:31], a[132:135], v[120:123], v[28:31]
    v_exp_f32 v140, v140
    v_mfma_f32_16x16x32_bf16 v[40:43], a[136:139], v[112:115], v[40:43]
    v_exp_f32 v141, v141
    v_mfma_f32_16x16x32_bf16 v[40:43], a[140:143], v[120:123], v[40:43]
    v_cvt_pk_bf16_f32 v136, v136, v137
    v_cvt_pk_bf16_f32 v137, v138, v139
    v_mfma_f32_16x16x32_bf16 v[52:55], a[144:147], v[112:115], v[52:55]
    v_exp_f32 v142, v142
    v_mfma_f32_16x16x32_bf16 v[52:55], a[148:151], v[120:123], v[52:55]
    v_exp_f32 v143, v143
    v_mfma_f32_16x16x32_bf16 v[64:67], a[152:155], v[112:115], v[64:67]
    v_exp_f32 v144, v144
    v_mfma_f32_16x16x32_bf16 v[64:67], a[156:159], v[120:123], v[64:67]
    v_cvt_pk_bf16_f32 v138, v140, v141
    v_cvt_pk_bf16_f32 v139, v142, v143
    v_mfma_f32_16x16x32_bf16 v[76:79], a[160:163], v[112:115], v[76:79]
    v_exp_f32 v145, v145
    v_mfma_f32_16x16x32_bf16 v[76:79], a[164:167], v[120:123], v[76:79]
    v_exp_f32 v146, v146
    v_mfma_f32_16x16x32_bf16 v[88:91], a[168:171], v[112:115], v[88:91]
    v_exp_f32 v147, v147
    v_mfma_f32_16x16x32_bf16 v[88:91], a[172:175], v[120:123], v[88:91]
    v_exp_f32 v148, v148
    v_mfma_f32_16x16x32_bf16 v[104:107], a[176:179], v[128:131], v[104:107]
    v_exp_f32 v149, v149
    v_mfma_f32_16x16x32_bf16 v[104:107], a[176:179], v[136:139], v[104:107]
    v_cvt_pk_bf16_f32 v144, v144, v145
    v_cvt_pk_bf16_f32 v145, v146, v147
    v_mfma_f32_16x16x32_bf16 v[8:11], a[112:115], v[128:131], v[8:11]
    v_exp_f32 v150, v150
    v_mfma_f32_16x16x32_bf16 v[8:11], a[116:119], v[136:139], v[8:11]
    v_exp_f32 v151, v151
    v_mfma_f32_16x16x32_bf16 v[20:23], a[120:123], v[128:131], v[20:23]
    v_exp_f32 v152, v152
    v_mfma_f32_16x16x32_bf16 v[20:23], a[124:127], v[136:139], v[20:23]
    v_cvt_pk_bf16_f32 v146, v148, v149
    v_cvt_pk_bf16_f32 v147, v150, v151
    v_mfma_f32_16x16x32_bf16 v[32:35], a[128:131], v[128:131], v[32:35]
    v_exp_f32 v153, v153
    v_mfma_f32_16x16x32_bf16 v[32:35], a[132:135], v[136:139], v[32:35]
    v_exp_f32 v154, v154
    v_mfma_f32_16x16x32_bf16 v[44:47], a[136:139], v[128:131], v[44:47]
    v_exp_f32 v155, v155
    v_mfma_f32_16x16x32_bf16 v[44:47], a[140:143], v[136:139], v[44:47]
    v_cvt_pk_bf16_f32 v152, v152, v153
    v_cvt_pk_bf16_f32 v153, v154, v155
    v_mfma_f32_16x16x32_bf16 v[56:59], a[144:147], v[128:131], v[56:59]
    v_exp_f32 v156, v156
    v_mfma_f32_16x16x32_bf16 v[56:59], a[148:151], v[136:139], v[56:59]
    v_exp_f32 v157, v157
    v_mfma_f32_16x16x32_bf16 v[68:71], a[152:155], v[128:131], v[68:71]
    v_exp_f32 v158, v158
    v_mfma_f32_16x16x32_bf16 v[68:71], a[156:159], v[136:139], v[68:71]
    v_exp_f32 v159, v159
    v_mfma_f32_16x16x32_bf16 v[80:83], a[160:163], v[128:131], v[80:83]
    v_cvt_pk_bf16_f32 v154, v156, v157
    v_cvt_pk_bf16_f32 v155, v158, v159
    v_mfma_f32_16x16x32_bf16 v[80:83], a[164:167], v[136:139], v[80:83]
    s_waitcnt vmcnt(4)
    s_barrier
    ds_read_b128 a[48:51], v172 offset:0
    ds_read_b128 a[52:55], v173 offset:0
    v_mfma_f32_16x16x32_bf16 v[92:95], a[168:171], v[128:131], v[92:95]
    ds_read_b128 a[56:59], v174 offset:0
    v_mfma_f32_16x16x32_bf16 v[92:95], a[172:175], v[136:139], v[92:95]
    ds_read_b128 a[60:63], v175 offset:0
    v_mfma_f32_16x16x32_bf16 v[108:111], a[176:179], v[144:147], v[108:111]
    ds_read_b128 a[64:67], v172 offset:4096
    v_mfma_f32_16x16x32_bf16 v[108:111], a[176:179], v[152:155], v[108:111]
    ds_read_b128 a[68:71], v173 offset:4096
    v_mfma_f32_16x16x32_bf16 v[12:15], a[112:115], v[144:147], v[12:15]
    s_add_u32 m0, s43, 16384
    ds_read_b128 a[72:75], v174 offset:4096
    v_mfma_f32_16x16x32_bf16 v[12:15], a[116:119], v[152:155], v[12:15]
    s_add_u32 s28, s28, 16384
    buffer_load_dwordx4 v186, s[16:19], s28 offen offset:0 nt lds
    v_mfma_f32_16x16x32_bf16 v[24:27], a[120:123], v[144:147], v[24:27]
    ds_read_b128 a[76:79], v175 offset:4096
    v_mfma_f32_16x16x32_bf16 v[24:27], a[124:127], v[152:155], v[24:27]
    ds_read_b128 a[80:83], v172 offset:8192
    v_mfma_f32_16x16x32_bf16 v[36:39], a[128:131], v[144:147], v[36:39]
    ds_read_b128 a[84:87], v173 offset:8192
    v_mfma_f32_16x16x32_bf16 v[36:39], a[132:135], v[152:155], v[36:39]
    buffer_load_dwordx4 v187, s[16:19], s28 offen offset:1024 nt lds
    v_mfma_f32_16x16x32_bf16 v[48:51], a[136:139], v[144:147], v[48:51]
    ds_read_b128 a[88:91], v174 offset:8192
    v_mfma_f32_16x16x32_bf16 v[48:51], a[140:143], v[152:155], v[48:51]
    ds_read_b128 a[92:95], v175 offset:8192
    v_mfma_f32_16x16x32_bf16 v[60:63], a[144:147], v[144:147], v[60:63]
    ds_read_b128 a[96:99], v172 offset:12288
    v_mfma_f32_16x16x32_bf16 v[60:63], a[148:151], v[152:155], v[60:63]
    buffer_load_dwordx4 v186, s[16:19], s28 offen offset:2048 nt lds
    v_mfma_f32_16x16x32_bf16 v[72:75], a[152:155], v[144:147], v[72:75]
    ds_read_b128 a[100:103], v173 offset:12288
    v_mfma_f32_16x16x32_bf16 v[72:75], a[156:159], v[152:155], v[72:75]
    ds_read_b128 a[104:107], v174 offset:12288
    v_mfma_f32_16x16x32_bf16 v[84:87], a[160:163], v[144:147], v[84:87]
    ds_read_b128 a[108:111], v175 offset:12288
    v_mfma_f32_16x16x32_bf16 v[84:87], a[164:167], v[152:155], v[84:87]
    buffer_load_dwordx4 v187, s[16:19], s28 offen offset:3072 nt lds
    v_mfma_f32_16x16x32_bf16 v[96:99], a[168:171], v[144:147], v[96:99]
    v_mfma_f32_16x16x32_bf16 v[96:99], a[172:175], v[152:155], v[96:99]
    s_waitcnt vmcnt(4) lgkmcnt(0)
    s_barrier
    ds_read_b64_tr_b16 a[112:113], v176 offset:0
    ds_read_b64_tr_b16 a[114:115], v176 offset:4096
    v_mfma_f32_16x16x32_bf16 v[112:115], a[48:51], a[0:3], v[160:163]
    ds_read_b64_tr_b16 a[116:117], v176 offset:8192
    v_mfma_f32_16x16x32_bf16 v[112:115], a[52:55], a[4:7], v[112:115]
    ds_read_b64_tr_b16 a[118:119], v176 offset:12288
    v_mfma_f32_16x16x32_bf16 v[112:115], a[56:59], a[8:11], v[112:115]
    ds_read_b64_tr_b16 a[120:121], v177 offset:0
    v_mfma_f32_16x16x32_bf16 v[112:115], a[60:63], a[12:15], v[112:115]
    ds_read_b64_tr_b16 a[122:123], v177 offset:4096
    ds_read_b64_tr_b16 a[124:125], v177 offset:8192
    v_mfma_f32_16x16x32_bf16 v[116:119], a[64:67], a[0:3], v[160:163]
    ds_read_b64_tr_b16 a[126:127], v177 offset:12288
    v_mfma_f32_16x16x32_bf16 v[116:119], a[68:71], a[4:7], v[116:119]
    ds_read_b64_tr_b16 a[128:129], v178 offset:0
    v_mfma_f32_16x16x32_bf16 v[116:119], a[72:75], a[8:11], v[116:119]
    ds_read_b64_tr_b16 a[130:131], v178 offset:4096
    v_mfma_f32_16x16x32_bf16 v[116:119], a[76:79], a[12:15], v[116:119]
    ds_read_b64_tr_b16 a[132:133], v178 offset:8192
    ds_read_b64_tr_b16 a[134:135], v178 offset:12288
    ds_read_b64_tr_b16 a[136:137], v179 offset:0
    v_mfma_f32_16x16x32_bf16 v[120:123], a[80:83], a[0:3], v[160:163]
    v_exp_f32 v112, v112
    v_mfma_f32_16x16x32_bf16 v[120:123], a[84:87], a[4:7], v[120:123]
    v_exp_f32 v113, v113
    v_mfma_f32_16x16x32_bf16 v[120:123], a[88:91], a[8:11], v[120:123]
    v_exp_f32 v114, v114
    v_mfma_f32_16x16x32_bf16 v[120:123], a[92:95], a[12:15], v[120:123]
    ds_read_b64_tr_b16 a[138:139], v179 offset:4096
    ds_read_b64_tr_b16 a[140:141], v179 offset:8192
    ds_read_b64_tr_b16 a[142:143], v179 offset:12288
    v_mfma_f32_16x16x32_bf16 v[124:127], a[96:99], a[0:3], v[160:163]
    ds_read_b64_tr_b16 a[144:145], v180 offset:0
    v_cvt_pk_bf16_f32 v112, v112, v113
    v_mfma_f32_16x16x32_bf16 v[124:127], a[100:103], a[4:7], v[124:127]
    v_exp_f32 v115, v115
    v_mfma_f32_16x16x32_bf16 v[124:127], a[104:107], a[8:11], v[124:127]
    v_exp_f32 v116, v116
    v_mfma_f32_16x16x32_bf16 v[124:127], a[108:111], a[12:15], v[124:127]
    ds_read_b64_tr_b16 a[146:147], v180 offset:4096
    ds_read_b64_tr_b16 a[148:149], v180 offset:8192
    v_mfma_f32_16x16x32_bf16 v[128:131], a[48:51], a[16:19], v[164:167]
    ds_read_b64_tr_b16 a[150:151], v180 offset:12288
    v_cvt_pk_bf16_f32 v113, v114, v115
    v_mfma_f32_16x16x32_bf16 v[128:131], a[52:55], a[20:23], v[128:131]
    v_exp_f32 v117, v117
    v_mfma_f32_16x16x32_bf16 v[128:131], a[56:59], a[24:27], v[128:131]
    v_exp_f32 v118, v118
    v_mfma_f32_16x16x32_bf16 v[128:131], a[60:63], a[28:31], v[128:131]
    ds_read_b64_tr_b16 a[152:153], v181 offset:0
    ds_read_b64_tr_b16 a[154:155], v181 offset:4096
    v_mfma_f32_16x16x32_bf16 v[132:135], a[64:67], a[16:19], v[164:167]
    ds_read_b64_tr_b16 a[156:157], v181 offset:8192
    v_cvt_pk_bf16_f32 v114, v116, v117
    v_mfma_f32_16x16x32_bf16 v[132:135], a[68:71], a[20:23], v[132:135]
    v_exp_f32 v119, v119
    v_mfma_f32_16x16x32_bf16 v[132:135], a[72:75], a[24:27], v[132:135]
    v_exp_f32 v120, v120
    v_mfma_f32_16x16x32_bf16 v[132:135], a[76:79], a[28:31], v[132:135]
    ds_read_b64_tr_b16 a[158:159], v181 offset:12288
    ds_read_b64_tr_b16 a[160:161], v182 offset:0
    v_mfma_f32_16x16x32_bf16 v[136:139], a[80:83], a[16:19], v[164:167]
    ds_read_b64_tr_b16 a[162:163], v182 offset:4096
    v_cvt_pk_bf16_f32 v115, v118, v119
    v_mfma_f32_16x16x32_bf16 v[136:139], a[84:87], a[20:23], v[136:139]
    v_exp_f32 v121, v121
    v_mfma_f32_16x16x32_bf16 v[136:139], a[88:91], a[24:27], v[136:139]
    s_add_u32 m0, s43, 49152
    v_exp_f32 v122, v122
    v_mfma_f32_16x16x32_bf16 v[136:139], a[92:95], a[28:31], v[136:139]
    s_add_u32 s29, s29, 16384
    buffer_load_dwordx4 v186, s[20:23], s29 offen offset:0 nt lds
    v_mfma_f32_16x16x32_bf16 v[140:143], a[96:99], a[16:19], v[164:167]
    ds_read_b64_tr_b16 a[164:165], v182 offset:8192
    v_cvt_pk_bf16_f32 v120, v120, v121
    v_mfma_f32_16x16x32_bf16 v[140:143], a[100:103], a[20:23], v[140:143]
    v_exp_f32 v123, v123
    v_mfma_f32_16x16x32_bf16 v[140:143], a[104:107], a[24:27], v[140:143]
    v_exp_f32 v124, v124
    v_mfma_f32_16x16x32_bf16 v[140:143], a[108:111], a[28:31], v[140:143]
    buffer_load_dwordx4 v187, s[20:23], s29 offen offset:1024 nt lds
    v_mfma_f32_16x16x32_bf16 v[144:147], a[48:51], a[32:35], v[168:171]
    ds_read_b64_tr_b16 a[166:167], v182 offset:12288
    v_cvt_pk_bf16_f32 v121, v122, v123
    v_mfma_f32_16x16x32_bf16 v[144:147], a[52:55], a[36:39], v[144:147]
    v_exp_f32 v125, v125
    v_mfma_f32_16x16x32_bf16 v[144:147], a[56:59], a[40:43], v[144:147]
    v_exp_f32 v126, v126
    v_mfma_f32_16x16x32_bf16 v[144:147], a[60:63], a[44:47], v[144:147]
    buffer_load_dwordx4 v186, s[20:23], s29 offen offset:2048 nt lds
    v_mfma_f32_16x16x32_bf16 v[148:151], a[64:67], a[32:35], v[168:171]
    ds_read_b64_tr_b16 a[168:169], v183 offset:0
    v_cvt_pk_bf16_f32 v122, v124, v125
    v_mfma_f32_16x16x32_bf16 v[148:151], a[68:71], a[36:39], v[148:151]
    v_exp_f32 v127, v127
    v_mfma_f32_16x16x32_bf16 v[148:151], a[72:75], a[40:43], v[148:151]
    ds_read_b64_tr_b16 a[170:171], v183 offset:4096
    v_cvt_pk_bf16_f32 v123, v126, v127
    v_mfma_f32_16x16x32_bf16 v[148:151], a[76:79], a[44:47], v[148:151]
    buffer_load_dwordx4 v187, s[20:23], s29 offen offset:3072 nt lds
    v_mfma_f32_16x16x32_bf16 v[152:155], a[80:83], a[32:35], v[168:171]
    v_exp_f32 v128, v128
    v_mfma_f32_16x16x32_bf16 v[152:155], a[84:87], a[36:39], v[152:155]
    v_exp_f32 v129, v129
    v_mfma_f32_16x16x32_bf16 v[152:155], a[88:91], a[40:43], v[152:155]
    v_exp_f32 v130, v130
    v_mfma_f32_16x16x32_bf16 v[152:155], a[92:95], a[44:47], v[152:155]
    ds_read_b64_tr_b16 a[172:173], v183 offset:8192
    ds_read_b64_tr_b16 a[174:175], v183 offset:12288
    v_mfma_f32_16x16x32_bf16 v[156:159], a[96:99], a[32:35], v[168:171]
    v_exp_f32 v131, v131
    v_mfma_f32_16x16x32_bf16 v[156:159], a[100:103], a[36:39], v[156:159]
    v_exp_f32 v132, v132
    v_mfma_f32_16x16x32_bf16 v[156:159], a[104:107], a[40:43], v[156:159]
    v_exp_f32 v133, v133
    v_mfma_f32_16x16x32_bf16 v[156:159], a[108:111], a[44:47], v[156:159]
    v_exp_f32 v134, v134
    v_mfma_f32_16x16x32_bf16 v[100:103], a[176:179], v[112:115], v[100:103]
    v_exp_f32 v135, v135
    v_mfma_f32_16x16x32_bf16 v[100:103], a[176:179], v[120:123], v[100:103]
    s_waitcnt lgkmcnt(0)
    v_cvt_pk_bf16_f32 v128, v128, v129
    v_cvt_pk_bf16_f32 v129, v130, v131
    v_mfma_f32_16x16x32_bf16 v[4:7], a[112:115], v[112:115], v[4:7]
    v_exp_f32 v136, v136
    v_mfma_f32_16x16x32_bf16 v[4:7], a[116:119], v[120:123], v[4:7]
    v_exp_f32 v137, v137
    v_mfma_f32_16x16x32_bf16 v[16:19], a[120:123], v[112:115], v[16:19]
    v_exp_f32 v138, v138
    v_mfma_f32_16x16x32_bf16 v[16:19], a[124:127], v[120:123], v[16:19]
    v_cvt_pk_bf16_f32 v130, v132, v133
    v_cvt_pk_bf16_f32 v131, v134, v135
    v_mfma_f32_16x16x32_bf16 v[28:31], a[128:131], v[112:115], v[28:31]
    v_exp_f32 v139, v139
    v_mfma_f32_16x16x32_bf16 v[28:31], a[132:135], v[120:123], v[28:31]
    v_exp_f32 v140, v140
    v_mfma_f32_16x16x32_bf16 v[40:43], a[136:139], v[112:115], v[40:43]
    v_exp_f32 v141, v141
    v_mfma_f32_16x16x32_bf16 v[40:43], a[140:143], v[120:123], v[40:43]
    v_cvt_pk_bf16_f32 v136, v136, v137
    v_cvt_pk_bf16_f32 v137, v138, v139
    v_mfma_f32_16x16x32_bf16 v[52:55], a[144:147], v[112:115], v[52:55]
    v_exp_f32 v142, v142
    v_mfma_f32_16x16x32_bf16 v[52:55], a[148:151], v[120:123], v[52:55]
    v_exp_f32 v143, v143
    v_mfma_f32_16x16x32_bf16 v[64:67], a[152:155], v[112:115], v[64:67]
    v_exp_f32 v144, v144
    v_mfma_f32_16x16x32_bf16 v[64:67], a[156:159], v[120:123], v[64:67]
    v_cvt_pk_bf16_f32 v138, v140, v141
    v_cvt_pk_bf16_f32 v139, v142, v143
    v_mfma_f32_16x16x32_bf16 v[76:79], a[160:163], v[112:115], v[76:79]
    v_exp_f32 v145, v145
    v_mfma_f32_16x16x32_bf16 v[76:79], a[164:167], v[120:123], v[76:79]
    v_exp_f32 v146, v146
    v_mfma_f32_16x16x32_bf16 v[88:91], a[168:171], v[112:115], v[88:91]
    v_exp_f32 v147, v147
    v_mfma_f32_16x16x32_bf16 v[88:91], a[172:175], v[120:123], v[88:91]
    v_exp_f32 v148, v148
    v_mfma_f32_16x16x32_bf16 v[104:107], a[176:179], v[128:131], v[104:107]
    v_exp_f32 v149, v149
    v_mfma_f32_16x16x32_bf16 v[104:107], a[176:179], v[136:139], v[104:107]
    v_cvt_pk_bf16_f32 v144, v144, v145
    v_cvt_pk_bf16_f32 v145, v146, v147
    v_mfma_f32_16x16x32_bf16 v[8:11], a[112:115], v[128:131], v[8:11]
    v_exp_f32 v150, v150
    v_mfma_f32_16x16x32_bf16 v[8:11], a[116:119], v[136:139], v[8:11]
    v_exp_f32 v151, v151
    v_mfma_f32_16x16x32_bf16 v[20:23], a[120:123], v[128:131], v[20:23]
    v_exp_f32 v152, v152
    v_mfma_f32_16x16x32_bf16 v[20:23], a[124:127], v[136:139], v[20:23]
    v_cvt_pk_bf16_f32 v146, v148, v149
    v_cvt_pk_bf16_f32 v147, v150, v151
    v_mfma_f32_16x16x32_bf16 v[32:35], a[128:131], v[128:131], v[32:35]
    v_exp_f32 v153, v153
    v_mfma_f32_16x16x32_bf16 v[32:35], a[132:135], v[136:139], v[32:35]
    v_exp_f32 v154, v154
    v_mfma_f32_16x16x32_bf16 v[44:47], a[136:139], v[128:131], v[44:47]
    v_exp_f32 v155, v155
    v_mfma_f32_16x16x32_bf16 v[44:47], a[140:143], v[136:139], v[44:47]
    v_cvt_pk_bf16_f32 v152, v152, v153
    v_cvt_pk_bf16_f32 v153, v154, v155
    v_mfma_f32_16x16x32_bf16 v[56:59], a[144:147], v[128:131], v[56:59]
    v_exp_f32 v156, v156
    v_mfma_f32_16x16x32_bf16 v[56:59], a[148:151], v[136:139], v[56:59]
    v_exp_f32 v157, v157
    v_mfma_f32_16x16x32_bf16 v[68:71], a[152:155], v[128:131], v[68:71]
    v_exp_f32 v158, v158
    v_mfma_f32_16x16x32_bf16 v[68:71], a[156:159], v[136:139], v[68:71]
    v_exp_f32 v159, v159
    v_mfma_f32_16x16x32_bf16 v[80:83], a[160:163], v[128:131], v[80:83]
    v_cvt_pk_bf16_f32 v154, v156, v157
    v_cvt_pk_bf16_f32 v155, v158, v159
    v_mfma_f32_16x16x32_bf16 v[80:83], a[164:167], v[136:139], v[80:83]
    s_waitcnt vmcnt(4)
    s_barrier
    ds_read_b128 a[48:51], v172 offset:16384
    ds_read_b128 a[52:55], v173 offset:16384
    v_mfma_f32_16x16x32_bf16 v[92:95], a[168:171], v[128:131], v[92:95]
    ds_read_b128 a[56:59], v174 offset:16384
    v_mfma_f32_16x16x32_bf16 v[92:95], a[172:175], v[136:139], v[92:95]
    ds_read_b128 a[60:63], v175 offset:16384
    v_mfma_f32_16x16x32_bf16 v[108:111], a[176:179], v[144:147], v[108:111]
    ds_read_b128 a[64:67], v172 offset:20480
    v_mfma_f32_16x16x32_bf16 v[108:111], a[176:179], v[152:155], v[108:111]
    ds_read_b128 a[68:71], v173 offset:20480
    v_mfma_f32_16x16x32_bf16 v[12:15], a[112:115], v[144:147], v[12:15]
    s_add_u32 m0, s43, 0
    ds_read_b128 a[72:75], v174 offset:20480
    v_mfma_f32_16x16x32_bf16 v[12:15], a[116:119], v[152:155], v[12:15]
    s_add_u32 s28, s28, 16384
    buffer_load_dwordx4 v186, s[16:19], s28 offen offset:0 nt lds
    v_mfma_f32_16x16x32_bf16 v[24:27], a[120:123], v[144:147], v[24:27]
    ds_read_b128 a[76:79], v175 offset:20480
    v_mfma_f32_16x16x32_bf16 v[24:27], a[124:127], v[152:155], v[24:27]
    ds_read_b128 a[80:83], v172 offset:24576
    v_mfma_f32_16x16x32_bf16 v[36:39], a[128:131], v[144:147], v[36:39]
    ds_read_b128 a[84:87], v173 offset:24576
    v_mfma_f32_16x16x32_bf16 v[36:39], a[132:135], v[152:155], v[36:39]
    buffer_load_dwordx4 v187, s[16:19], s28 offen offset:1024 nt lds
    v_mfma_f32_16x16x32_bf16 v[48:51], a[136:139], v[144:147], v[48:51]
    ds_read_b128 a[88:91], v174 offset:24576
    v_mfma_f32_16x16x32_bf16 v[48:51], a[140:143], v[152:155], v[48:51]
    ds_read_b128 a[92:95], v175 offset:24576
    v_mfma_f32_16x16x32_bf16 v[60:63], a[144:147], v[144:147], v[60:63]
    ds_read_b128 a[96:99], v172 offset:28672
    v_mfma_f32_16x16x32_bf16 v[60:63], a[148:151], v[152:155], v[60:63]
    buffer_load_dwordx4 v186, s[16:19], s28 offen offset:2048 nt lds
    v_mfma_f32_16x16x32_bf16 v[72:75], a[152:155], v[144:147], v[72:75]
    ds_read_b128 a[100:103], v173 offset:28672
    v_mfma_f32_16x16x32_bf16 v[72:75], a[156:159], v[152:155], v[72:75]
    s_sub_u32 s32, s32, 1
    ds_read_b128 a[104:107], v174 offset:28672
    v_mfma_f32_16x16x32_bf16 v[84:87], a[160:163], v[144:147], v[84:87]
    ds_read_b128 a[108:111], v175 offset:28672
    v_mfma_f32_16x16x32_bf16 v[84:87], a[164:167], v[152:155], v[84:87]
    buffer_load_dwordx4 v187, s[16:19], s28 offen offset:3072 nt lds
    v_mfma_f32_16x16x32_bf16 v[96:99], a[168:171], v[144:147], v[96:99]
    s_cmp_lg_u32 s32, s33
    v_mfma_f32_16x16x32_bf16 v[96:99], a[172:175], v[152:155], v[96:99]
    s_cbranch_scc1 LOOP1
    s_waitcnt lgkmcnt(0)
    v_mfma_f32_16x16x32_bf16 v[112:115], a[48:51], a[0:3], v[160:163]
    ds_read_b64_tr_b16 a[112:113], v176 offset:32768
    ds_read_b64_tr_b16 a[114:115], v176 offset:36864
    v_mfma_f32_16x16x32_bf16 v[112:115], a[52:55], a[4:7], v[112:115]
    ds_read_b64_tr_b16 a[116:117], v176 offset:40960
    v_mfma_f32_16x16x32_bf16 v[112:115], a[56:59], a[8:11], v[112:115]
    ds_read_b64_tr_b16 a[118:119], v176 offset:45056
    ds_read_b64_tr_b16 a[120:121], v177 offset:32768
    v_mfma_f32_16x16x32_bf16 v[112:115], a[60:63], a[12:15], v[112:115]
    ds_read_b64_tr_b16 a[122:123], v177 offset:36864
    v_mfma_f32_16x16x32_bf16 v[116:119], a[64:67], a[0:3], v[160:163]
PAD3:
    s_cbranch_execz TOUCH_RET
    ds_read_b64_tr_b16 a[124:125], v177 offset:40960
    ds_read_b64_tr_b16 a[126:127], v177 offset:45056
    v_mfma_f32_16x16x32_bf16 v[116:119], a[68:71], a[4:7], v[116:119]
    ds_read_b64_tr_b16 a[128:129], v178 offset:32768
    v_mfma_f32_16x16x32_bf16 v[116:119], a[72:75], a[8:11], v[116:119]
    ds_read_b64_tr_b16 a[130:131], v178 offset:36864
    ds_read_b64_tr_b16 a[132:133], v178 offset:40960
    v_mfma_f32_16x16x32_bf16 v[116:119], a[76:79], a[12:15], v[116:119]
    ds_read_b64_tr_b16 a[134:135], v178 offset:45056
    v_mfma_f32_16x16x32_bf16 v[120:123], a[80:83], a[0:3], v[160:163]
    ds_read_b64_tr_b16 a[136:137], v179 offset:32768
    ds_read_b64_tr_b16 a[138:139], v179 offset:36864
    v_mfma_f32_16x16x32_bf16 v[120:123], a[84:87], a[4:7], v[120:123]
    v_exp_f32 v112, v112
    v_mfma_f32_16x16x32_bf16 v[120:123], a[88:91], a[8:11], v[120:123]
    ds_read_b64_tr_b16 a[140:141], v179 offset:40960
    v_exp_f32 v113, v113
    v_mfma_f32_16x16x32_bf16 v[120:123], a[92:95], a[12:15], v[120:123]
    ds_read_b64_tr_b16 a[142:143], v179 offset:45056
    v_exp_f32 v114, v114
    v_mfma_f32_16x16x32_bf16 v[124:127], a[96:99], a[0:3], v[160:163]
    ds_read_b64_tr_b16 a[144:145], v180 offset:32768
    v_cvt_pk_bf16_f32 v112, v112, v113
    v_mfma_f32_16x16x32_bf16 v[124:127], a[100:103], a[4:7], v[124:127]
    ds_read_b64_tr_b16 a[146:147], v180 offset:36864
    v_exp_f32 v115, v115
    v_mfma_f32_16x16x32_bf16 v[124:127], a[104:107], a[8:11], v[124:127]
    ds_read_b64_tr_b16 a[148:149], v180 offset:40960
    v_exp_f32 v116, v116
    v_mfma_f32_16x16x32_bf16 v[124:127], a[108:111], a[12:15], v[124:127]
    ds_read_b64_tr_b16 a[150:151], v180 offset:45056
    v_cvt_pk_bf16_f32 v113, v114, v115
    v_mfma_f32_16x16x32_bf16 v[128:131], a[48:51], a[16:19], v[164:167]
    ds_read_b64_tr_b16 a[152:153], v181 offset:32768
    v_exp_f32 v117, v117
    v_mfma_f32_16x16x32_bf16 v[128:131], a[52:55], a[20:23], v[128:131]
    ds_read_b64_tr_b16 a[154:155], v181 offset:36864
    v_exp_f32 v118, v118
    v_mfma_f32_16x16x32_bf16 v[128:131], a[56:59], a[24:27], v[128:131]
    ds_read_b64_tr_b16 a[156:157], v181 offset:40960
    v_cvt_pk_bf16_f32 v114, v116, v117
    v_exp_f32 v119, v119
    v_mfma_f32_16x16x32_bf16 v[128:131], a[60:63], a[28:31], v[128:131]
    ds_read_b64_tr_b16 a[158:159], v181 offset:45056
    v_mfma_f32_16x16x32_bf16 v[132:135], a[64:67], a[16:19], v[164:167]
    ds_read_b64_tr_b16 a[160:161], v182 offset:32768
    v_exp_f32 v120, v120
    v_cvt_pk_bf16_f32 v115, v118, v119
    v_mfma_f32_16x16x32_bf16 v[132:135], a[68:71], a[20:23], v[132:135]
    ds_read_b64_tr_b16 a[162:163], v182 offset:36864
    v_exp_f32 v121, v121
    v_mfma_f32_16x16x32_bf16 v[132:135], a[72:75], a[24:27], v[132:135]
    ds_read_b64_tr_b16 a[164:165], v182 offset:40960
    v_exp_f32 v122, v122
    v_mfma_f32_16x16x32_bf16 v[132:135], a[76:79], a[28:31], v[132:135]
    ds_read_b64_tr_b16 a[166:167], v182 offset:45056
    v_cvt_pk_bf16_f32 v120, v120, v121
    v_mfma_f32_16x16x32_bf16 v[136:139], a[80:83], a[16:19], v[164:167]
    ds_read_b64_tr_b16 a[168:169], v183 offset:32768
    v_exp_f32 v123, v123
    v_mfma_f32_16x16x32_bf16 v[136:139], a[84:87], a[20:23], v[136:139]
    ds_read_b64_tr_b16 a[170:171], v183 offset:36864
    v_exp_f32 v124, v124
    v_mfma_f32_16x16x32_bf16 v[136:139], a[88:91], a[24:27], v[136:139]
    ds_read_b64_tr_b16 a[172:173], v183 offset:40960
    v_cvt_pk_bf16_f32 v121, v122, v123
    v_mfma_f32_16x16x32_bf16 v[136:139], a[92:95], a[28:31], v[136:139]
    ds_read_b64_tr_b16 a[174:175], v183 offset:45056
    v_exp_f32 v125, v125
    v_mfma_f32_16x16x32_bf16 v[140:143], a[96:99], a[16:19], v[164:167]
    v_exp_f32 v126, v126
    v_mfma_f32_16x16x32_bf16 v[140:143], a[100:103], a[20:23], v[140:143]
    v_cvt_pk_bf16_f32 v122, v124, v125
    v_exp_f32 v127, v127
    v_mfma_f32_16x16x32_bf16 v[140:143], a[104:107], a[24:27], v[140:143]
    v_cvt_pk_bf16_f32 v123, v126, v127
    v_mfma_f32_16x16x32_bf16 v[140:143], a[108:111], a[28:31], v[140:143]
    v_exp_f32 v128, v128
    v_mfma_f32_16x16x32_bf16 v[100:103], a[176:179], v[112:115], v[100:103]
    v_exp_f32 v129, v129
    v_mfma_f32_16x16x32_bf16 v[100:103], a[176:179], v[120:123], v[100:103]
    s_waitcnt lgkmcnt(0)
    v_exp_f32 v130, v130
    v_cvt_pk_bf16_f32 v128, v128, v129
    v_mfma_f32_16x16x32_bf16 v[4:7], a[112:115], v[112:115], v[4:7]
    v_exp_f32 v131, v131
    v_mfma_f32_16x16x32_bf16 v[4:7], a[116:119], v[120:123], v[4:7]
    v_exp_f32 v132, v132
    v_mfma_f32_16x16x32_bf16 v[16:19], a[120:123], v[112:115], v[16:19]
    v_cvt_pk_bf16_f32 v129, v130, v131
    v_exp_f32 v133, v133
    v_mfma_f32_16x16x32_bf16 v[16:19], a[124:127], v[120:123], v[16:19]
    v_exp_f32 v134, v134
    v_mfma_f32_16x16x32_bf16 v[28:31], a[128:131], v[112:115], v[28:31]
    v_cvt_pk_bf16_f32 v130, v132, v133
    v_mfma_f32_16x16x32_bf16 v[28:31], a[132:135], v[120:123], v[28:31]
    v_exp_f32 v135, v135
    v_mfma_f32_16x16x32_bf16 v[40:43], a[136:139], v[112:115], v[40:43]
    v_exp_f32 v136, v136
    v_cvt_pk_bf16_f32 v131, v134, v135
    v_mfma_f32_16x16x32_bf16 v[40:43], a[140:143], v[120:123], v[40:43]
    v_exp_f32 v137, v137
    v_mfma_f32_16x16x32_bf16 v[52:55], a[144:147], v[112:115], v[52:55]
    v_exp_f32 v138, v138
    v_cvt_pk_bf16_f32 v136, v136, v137
    v_mfma_f32_16x16x32_bf16 v[52:55], a[148:151], v[120:123], v[52:55]
    v_exp_f32 v139, v139
    v_mfma_f32_16x16x32_bf16 v[64:67], a[152:155], v[112:115], v[64:67]
    v_exp_f32 v140, v140
    v_mfma_f32_16x16x32_bf16 v[64:67], a[156:159], v[120:123], v[64:67]
    v_cvt_pk_bf16_f32 v137, v138, v139
    v_exp_f32 v141, v141
    v_mfma_f32_16x16x32_bf16 v[76:79], a[160:163], v[112:115], v[76:79]
    v_exp_f32 v142, v142
    v_mfma_f32_16x16x32_bf16 v[76:79], a[164:167], v[120:123], v[76:79]
    v_cvt_pk_bf16_f32 v138, v140, v141
    v_mfma_f32_16x16x32_bf16 v[88:91], a[168:171], v[112:115], v[88:91]
    v_exp_f32 v143, v143
    s_nop 0
    v_cvt_pk_bf16_f32 v139, v142, v143
    v_mfma_f32_16x16x32_bf16 v[88:91], a[172:175], v[120:123], v[88:91]
    v_rcp_f32 v160, v100
    v_mfma_f32_16x16x32_bf16 v[144:147], a[48:51], a[32:35], v[168:171]
    v_mul_f32 v4, v160, v4
    v_mul_f32 v5, v160, v5
    v_mul_f32 v6, v160, v6
    v_mfma_f32_16x16x32_bf16 v[144:147], a[52:55], a[36:39], v[144:147]
    v_mul_f32 v7, v160, v7
    v_cvt_pk_bf16_f32 v4, v4, v5
    v_cvt_pk_bf16_f32 v5, v6, v7
    v_mfma_f32_16x16x32_bf16 v[144:147], a[56:59], a[40:43], v[144:147]
    ds_write_b64 v188, v[4:5] offset:0
    v_mul_f32 v16, v160, v16
    v_mul_f32 v17, v160, v17
    v_mul_f32 v18, v160, v18
    v_mfma_f32_16x16x32_bf16 v[144:147], a[60:63], a[44:47], v[144:147]
    v_mul_f32 v19, v160, v19
    v_cvt_pk_bf16_f32 v16, v16, v17
    v_cvt_pk_bf16_f32 v17, v18, v19
    v_mfma_f32_16x16x32_bf16 v[148:151], a[64:67], a[32:35], v[168:171]
    ds_write_b64 v189, v[16:17] offset:0
    v_mul_f32 v28, v160, v28
    v_mul_f32 v29, v160, v29
    v_mul_f32 v30, v160, v30
    v_mfma_f32_16x16x32_bf16 v[148:151], a[68:71], a[36:39], v[148:151]
    v_mul_f32 v31, v160, v31
    v_cvt_pk_bf16_f32 v28, v28, v29
    v_cvt_pk_bf16_f32 v29, v30, v31
    v_mfma_f32_16x16x32_bf16 v[148:151], a[72:75], a[40:43], v[148:151]
    ds_write_b64 v190, v[28:29] offset:0
    v_mul_f32 v40, v160, v40
    v_mul_f32 v41, v160, v41
    v_mul_f32 v42, v160, v42
    v_mfma_f32_16x16x32_bf16 v[148:151], a[76:79], a[44:47], v[148:151]
    v_mul_f32 v43, v160, v43
    v_cvt_pk_bf16_f32 v40, v40, v41
    v_cvt_pk_bf16_f32 v41, v42, v43
    v_mfma_f32_16x16x32_bf16 v[152:155], a[80:83], a[32:35], v[168:171]
    ds_write_b64 v191, v[40:41] offset:0
    v_mul_f32 v52, v160, v52
    v_mul_f32 v53, v160, v53
    v_mul_f32 v54, v160, v54
    v_mfma_f32_16x16x32_bf16 v[152:155], a[84:87], a[36:39], v[152:155]
    v_mul_f32 v55, v160, v55
    v_cvt_pk_bf16_f32 v52, v52, v53
    v_cvt_pk_bf16_f32 v53, v54, v55
    v_mfma_f32_16x16x32_bf16 v[152:155], a[88:91], a[40:43], v[152:155]
    ds_write_b64 v192, v[52:53] offset:0
    v_mul_f32 v64, v160, v64
    v_mul_f32 v65, v160, v65
    v_mul_f32 v66, v160, v66
    v_mfma_f32_16x16x32_bf16 v[152:155], a[92:95], a[44:47], v[152:155]
    v_mul_f32 v67, v160, v67
    v_cvt_pk_bf16_f32 v64, v64, v65
    v_cvt_pk_bf16_f32 v65, v66, v67
    v_mfma_f32_16x16x32_bf16 v[156:159], a[96:99], a[32:35], v[168:171]
    ds_write_b64 v193, v[64:65] offset:0
    v_mul_f32 v76, v160, v76
    v_mul_f32 v77, v160, v77
    v_mul_f32 v78, v160, v78
    v_mfma_f32_16x16x32_bf16 v[156:159], a[100:103], a[36:39], v[156:159]
    v_mul_f32 v79, v160, v79
    v_cvt_pk_bf16_f32 v76, v76, v77
    v_cvt_pk_bf16_f32 v77, v78, v79
    v_mfma_f32_16x16x32_bf16 v[156:159], a[104:107], a[40:43], v[156:159]
    ds_write_b64 v194, v[76:77] offset:0
    v_mul_f32 v88, v160, v88
    v_mul_f32 v89, v160, v89
    v_mul_f32 v90, v160, v90
    v_mfma_f32_16x16x32_bf16 v[156:159], a[108:111], a[44:47], v[156:159]
    v_mul_f32 v91, v160, v91
    v_cvt_pk_bf16_f32 v88, v88, v89
    v_cvt_pk_bf16_f32 v89, v90, v91
    v_mfma_f32_16x16x32_bf16 v[104:107], a[176:179], v[128:131], v[104:107]
    ds_write_b64 v195, v[88:89] offset:0
    v_exp_f32 v144, v144
    v_mfma_f32_16x16x32_bf16 v[104:107], a[176:179], v[136:139], v[104:107]
    ds_read_b128 v[112:115], v196 offset:0
    ds_read_b128 v[116:119], v197 offset:0
    v_exp_f32 v145, v145
    v_mfma_f32_16x16x32_bf16 v[8:11], a[112:115], v[128:131], v[8:11]
    ds_read_b128 v[120:123], v198 offset:0
    ds_read_b128 v[124:127], v199 offset:0
    v_exp_f32 v146, v146
    v_cvt_pk_bf16_f32 v144, v144, v145
    v_mfma_f32_16x16x32_bf16 v[8:11], a[116:119], v[136:139], v[8:11]
    v_exp_f32 v147, v147
    v_mfma_f32_16x16x32_bf16 v[20:23], a[120:123], v[128:131], v[20:23]
    v_exp_f32 v148, v148
    v_cvt_pk_bf16_f32 v145, v146, v147
    v_mfma_f32_16x16x32_bf16 v[20:23], a[124:127], v[136:139], v[20:23]
    v_exp_f32 v149, v149
    v_mfma_f32_16x16x32_bf16 v[32:35], a[128:131], v[128:131], v[32:35]
    v_exp_f32 v150, v150
    v_mfma_f32_16x16x32_bf16 v[32:35], a[132:135], v[136:139], v[32:35]
    v_cvt_pk_bf16_f32 v146, v148, v149
    v_exp_f32 v151, v151
    v_mfma_f32_16x16x32_bf16 v[44:47], a[136:139], v[128:131], v[44:47]
    v_exp_f32 v152, v152
    v_mfma_f32_16x16x32_bf16 v[44:47], a[140:143], v[136:139], v[44:47]
    v_cvt_pk_bf16_f32 v147, v150, v151
    v_exp_f32 v153, v153
    v_mfma_f32_16x16x32_bf16 v[56:59], a[144:147], v[128:131], v[56:59]
    v_exp_f32 v154, v154
    v_mfma_f32_16x16x32_bf16 v[56:59], a[148:151], v[136:139], v[56:59]
    v_cvt_pk_bf16_f32 v152, v152, v153
    v_exp_f32 v155, v155
    v_mfma_f32_16x16x32_bf16 v[68:71], a[152:155], v[128:131], v[68:71]
    v_exp_f32 v156, v156
    v_mfma_f32_16x16x32_bf16 v[68:71], a[156:159], v[136:139], v[68:71]
    v_cvt_pk_bf16_f32 v153, v154, v155
    v_mfma_f32_16x16x32_bf16 v[80:83], a[160:163], v[128:131], v[80:83]
    v_exp_f32 v157, v157
    v_exp_f32 v158, v158
    v_mfma_f32_16x16x32_bf16 v[80:83], a[164:167], v[136:139], v[80:83]
    s_waitcnt lgkmcnt(3)
    buffer_store_dwordx4 v[112:115], v184, s[24:27], s40 offen offset:0 nt
    v_cvt_pk_bf16_f32 v154, v156, v157
    v_mfma_f32_16x16x32_bf16 v[92:95], a[168:171], v[128:131], v[92:95]
    v_exp_f32 v159, v159
    s_nop 0
    v_cvt_pk_bf16_f32 v155, v158, v159
    v_mfma_f32_16x16x32_bf16 v[92:95], a[172:175], v[136:139], v[92:95]
    v_rcp_f32 v164, v104
    v_mfma_f32_16x16x32_bf16 v[108:111], a[176:179], v[144:147], v[108:111]
    v_mul_f32 v8, v164, v8
    v_mul_f32 v9, v164, v9
    v_mul_f32 v10, v164, v10
    v_mfma_f32_16x16x32_bf16 v[108:111], a[176:179], v[152:155], v[108:111]
    s_waitcnt lgkmcnt(2)
    buffer_store_dwordx4 v[116:119], v184, s[24:27], s40 offen offset:1024 nt
    v_mul_f32 v11, v164, v11
    v_cvt_pk_bf16_f32 v8, v8, v9
    v_cvt_pk_bf16_f32 v9, v10, v11
    v_mfma_f32_16x16x32_bf16 v[12:15], a[112:115], v[144:147], v[12:15]
    ds_write_b64 v188, v[8:9] offset:4096
    v_mul_f32 v20, v164, v20
    v_mul_f32 v21, v164, v21
    v_mul_f32 v22, v164, v22
    v_mfma_f32_16x16x32_bf16 v[12:15], a[116:119], v[152:155], v[12:15]
    v_mul_f32 v23, v164, v23
    v_cvt_pk_bf16_f32 v20, v20, v21
    v_cvt_pk_bf16_f32 v21, v22, v23
    v_mfma_f32_16x16x32_bf16 v[24:27], a[120:123], v[144:147], v[24:27]
    ds_write_b64 v189, v[20:21] offset:4096
    v_mul_f32 v32, v164, v32
    v_mul_f32 v33, v164, v33
    v_mul_f32 v34, v164, v34
    v_mfma_f32_16x16x32_bf16 v[24:27], a[124:127], v[152:155], v[24:27]
    s_waitcnt lgkmcnt(3)
    buffer_store_dwordx4 v[120:123], v184, s[24:27], s40 offen offset:2048 nt
    v_mul_f32 v35, v164, v35
    v_cvt_pk_bf16_f32 v32, v32, v33
    v_cvt_pk_bf16_f32 v33, v34, v35
    v_mfma_f32_16x16x32_bf16 v[36:39], a[128:131], v[144:147], v[36:39]
    ds_write_b64 v190, v[32:33] offset:4096
    v_mul_f32 v44, v164, v44
    v_mul_f32 v45, v164, v45
    v_mul_f32 v46, v164, v46
    v_mfma_f32_16x16x32_bf16 v[36:39], a[132:135], v[152:155], v[36:39]
    v_mul_f32 v47, v164, v47
    v_cvt_pk_bf16_f32 v44, v44, v45
    v_cvt_pk_bf16_f32 v45, v46, v47
    v_mfma_f32_16x16x32_bf16 v[48:51], a[136:139], v[144:147], v[48:51]
    ds_write_b64 v191, v[44:45] offset:4096
    v_mul_f32 v56, v164, v56
    v_mul_f32 v57, v164, v57
    v_mul_f32 v58, v164, v58
    v_mfma_f32_16x16x32_bf16 v[48:51], a[140:143], v[152:155], v[48:51]
    s_waitcnt lgkmcnt(4)
    buffer_store_dwordx4 v[124:127], v184, s[24:27], s40 offen offset:3072 nt
    v_mul_f32 v59, v164, v59
    v_cvt_pk_bf16_f32 v56, v56, v57
    v_cvt_pk_bf16_f32 v57, v58, v59
    v_mfma_f32_16x16x32_bf16 v[60:63], a[144:147], v[144:147], v[60:63]
    ds_write_b64 v192, v[56:57] offset:4096
    v_mul_f32 v68, v164, v68
    v_mul_f32 v69, v164, v69
    v_mul_f32 v70, v164, v70
    v_mfma_f32_16x16x32_bf16 v[60:63], a[148:151], v[152:155], v[60:63]
    v_mul_f32 v71, v164, v71
    v_cvt_pk_bf16_f32 v68, v68, v69
    v_cvt_pk_bf16_f32 v69, v70, v71
    v_mfma_f32_16x16x32_bf16 v[72:75], a[152:155], v[144:147], v[72:75]
    ds_write_b64 v193, v[68:69] offset:4096
    v_mul_f32 v80, v164, v80
    v_mul_f32 v81, v164, v81
    v_mul_f32 v82, v164, v82
    v_mfma_f32_16x16x32_bf16 v[72:75], a[156:159], v[152:155], v[72:75]
    v_mul_f32 v83, v164, v83
    v_cvt_pk_bf16_f32 v80, v80, v81
    v_cvt_pk_bf16_f32 v81, v82, v83
    v_mfma_f32_16x16x32_bf16 v[84:87], a[160:163], v[144:147], v[84:87]
    ds_write_b64 v194, v[80:81] offset:4096
    v_mul_f32 v92, v164, v92
    v_mul_f32 v93, v164, v93
    v_mul_f32 v94, v164, v94
    v_mfma_f32_16x16x32_bf16 v[84:87], a[164:167], v[152:155], v[84:87]
    v_mul_f32 v95, v164, v95
    v_cvt_pk_bf16_f32 v92, v92, v93
    v_cvt_pk_bf16_f32 v93, v94, v95
    v_mfma_f32_16x16x32_bf16 v[96:99], a[168:171], v[144:147], v[96:99]
    ds_write_b64 v195, v[92:93] offset:4096
    v_add_f32 v204, v100, v104
    v_add_f32 v204, v108, v204
    v_mfma_f32_16x16x32_bf16 v[96:99], a[172:175], v[152:155], v[96:99]
    ds_read_b128 v[128:131], v196 offset:4096
    ds_read_b128 v[132:135], v197 offset:4096
    ds_read_b128 v[136:139], v198 offset:4096
    ds_read_b128 v[140:143], v199 offset:4096
    v_cmp_ngt_f32 vcc, s34, v204
    v_rcp_f32 v168, v108
    v_rcp_f32 v169, v109
    s_cbranch_vccnz FALLBACK
    v_pk_mul_f32 v[12:13], v[12:13], v[168:169]
    v_pk_mul_f32 v[14:15], v[14:15], v[168:169]
    v_cvt_pk_bf16_f32 v12, v12, v13
    v_cvt_pk_bf16_f32 v13, v14, v15
    v_pk_mul_f32 v[24:25], v[24:25], v[168:169]
    v_pk_mul_f32 v[26:27], v[26:27], v[168:169]
    v_cvt_pk_bf16_f32 v24, v24, v25
    v_cvt_pk_bf16_f32 v25, v26, v27
    ds_write_b64 v188, v[12:13] offset:8192
    ds_write_b64 v189, v[24:25] offset:8192
    s_waitcnt lgkmcnt(5)
    buffer_store_dwordx4 v[128:131], v184, s[24:27], s41 offen offset:0 nt
    v_pk_mul_f32 v[36:37], v[36:37], v[168:169]
    v_pk_mul_f32 v[38:39], v[38:39], v[168:169]
    v_cvt_pk_bf16_f32 v36, v36, v37
    v_cvt_pk_bf16_f32 v37, v38, v39
    v_pk_mul_f32 v[48:49], v[48:49], v[168:169]
    v_pk_mul_f32 v[50:51], v[50:51], v[168:169]
    v_cvt_pk_bf16_f32 v48, v48, v49
    v_cvt_pk_bf16_f32 v49, v50, v51
    ds_write_b64 v190, v[36:37] offset:8192
    ds_write_b64 v191, v[48:49] offset:8192
    s_waitcnt lgkmcnt(6)
    buffer_store_dwordx4 v[132:135], v184, s[24:27], s41 offen offset:1024 nt
    v_pk_mul_f32 v[60:61], v[60:61], v[168:169]
    v_pk_mul_f32 v[62:63], v[62:63], v[168:169]
    v_cvt_pk_bf16_f32 v60, v60, v61
    v_cvt_pk_bf16_f32 v61, v62, v63
    v_pk_mul_f32 v[72:73], v[72:73], v[168:169]
    v_pk_mul_f32 v[74:75], v[74:75], v[168:169]
    v_cvt_pk_bf16_f32 v72, v72, v73
    v_cvt_pk_bf16_f32 v73, v74, v75
    ds_write_b64 v192, v[60:61] offset:8192
    ds_write_b64 v193, v[72:73] offset:8192
    s_waitcnt lgkmcnt(7)
    buffer_store_dwordx4 v[136:139], v184, s[24:27], s41 offen offset:2048 nt
    v_pk_mul_f32 v[84:85], v[84:85], v[168:169]
    v_pk_mul_f32 v[86:87], v[86:87], v[168:169]
    v_cvt_pk_bf16_f32 v84, v84, v85
    v_cvt_pk_bf16_f32 v85, v86, v87
    v_pk_mul_f32 v[96:97], v[96:97], v[168:169]
    v_pk_mul_f32 v[98:99], v[98:99], v[168:169]
    v_cvt_pk_bf16_f32 v96, v96, v97
    v_cvt_pk_bf16_f32 v97, v98, v99
    ds_write_b64 v194, v[84:85] offset:8192
    ds_write_b64 v195, v[96:97] offset:8192
    ds_read_b128 v[144:147], v196 offset:8192
    ds_read_b128 v[148:151], v197 offset:8192
    ds_read_b128 v[152:155], v198 offset:8192
    ds_read_b128 v[156:159], v199 offset:8192
    s_waitcnt lgkmcnt(12)
    buffer_store_dwordx4 v[140:143], v184, s[24:27], s41 offen offset:3072 nt
    s_waitcnt lgkmcnt(3)
    buffer_store_dwordx4 v[144:147], v184, s[24:27], s42 offen offset:0 nt
    s_waitcnt lgkmcnt(2)
    buffer_store_dwordx4 v[148:151], v184, s[24:27], s42 offen offset:1024 nt
    s_waitcnt lgkmcnt(1)
    buffer_store_dwordx4 v[152:155], v184, s[24:27], s42 offen offset:2048 nt
    s_waitcnt lgkmcnt(0)
    buffer_store_dwordx4 v[156:159], v184, s[24:27], s42 offen offset:3072 nt
END:
    s_endpgm
CODE_END:
FALLBACK:
    s_nop 7
    v_mov_b32 v4, 0
    v_mov_b32 v5, 0
    v_mov_b32 v6, 0
    v_mov_b32 v7, 0
    v_mov_b32 v8, 0
    v_mov_b32 v9, 0
    v_mov_b32 v10, 0
    v_mov_b32 v11, 0
    v_mov_b32 v12, 0
    v_mov_b32 v13, 0
    v_mov_b32 v14, 0
    v_mov_b32 v15, 0
    v_mov_b32 v16, 0
    v_mov_b32 v17, 0
    v_mov_b32 v18, 0
    v_mov_b32 v19, 0
    v_mov_b32 v20, 0
    v_mov_b32 v21, 0
    v_mov_b32 v22, 0
    v_mov_b32 v23, 0
    v_mov_b32 v24, 0
    v_mov_b32 v25, 0
    v_mov_b32 v26, 0
    v_mov_b32 v27, 0
    v_mov_b32 v28, 0
    v_mov_b32 v29, 0
    v_mov_b32 v30, 0
    v_mov_b32 v31, 0
    v_mov_b32 v32, 0
    v_mov_b32 v33, 0
    v_mov_b32 v34, 0
    v_mov_b32 v35, 0
    v_mov_b32 v36, 0
    v_mov_b32 v37, 0
    v_mov_b32 v38, 0
    v_mov_b32 v39, 0
    v_mov_b32 v40, 0
    v_mov_b32 v41, 0
    v_mov_b32 v42, 0
    v_mov_b32 v43, 0
    v_mov_b32 v44, 0
    v_mov_b32 v45, 0
    v_mov_b32 v46, 0
    v_mov_b32 v47, 0
    v_mov_b32 v48, 0
    v_mov_b32 v49, 0
    v_mov_b32 v50, 0
    v_mov_b32 v51, 0
    v_mov_b32 v52, 0
    v_mov_b32 v53, 0
    v_mov_b32 v54, 0
    v_mov_b32 v55, 0
    v_mov_b32 v56, 0
    v_mov_b32 v57, 0
    v_mov_b32 v58, 0
    v_mov_b32 v59, 0
    v_mov_b32 v60, 0
    v_mov_b32 v61, 0
    v_mov_b32 v62, 0
    v_mov_b32 v63, 0
    v_mov_b32 v64, 0
    v_mov_b32 v65, 0
    v_mov_b32 v66, 0
    v_mov_b32 v67, 0
    v_mov_b32 v68, 0
    v_mov_b32 v69, 0
    v_mov_b32 v70, 0
    v_mov_b32 v71, 0
    v_mov_b32 v72, 0
    v_mov_b32 v73, 0
    v_mov_b32 v74, 0
    v_mov_b32 v75, 0
    v_mov_b32 v76, 0
    v_mov_b32 v77, 0
    v_mov_b32 v78, 0
    v_mov_b32 v79, 0
    v_mov_b32 v80, 0
    v_mov_b32 v81, 0
    v_mov_b32 v82, 0
    v_mov_b32 v83, 0
    v_mov_b32 v84, 0
    v_mov_b32 v85, 0
    v_mov_b32 v86, 0
    v_mov_b32 v87, 0
    v_mov_b32 v88, 0
    v_mov_b32 v89, 0
    v_mov_b32 v90, 0
    v_mov_b32 v91, 0
    v_mov_b32 v92, 0
    v_mov_b32 v93, 0
    v_mov_b32 v94, 0
    v_mov_b32 v95, 0
    v_mov_b32 v96, 0
    v_mov_b32 v97, 0
    v_mov_b32 v98, 0
    v_mov_b32 v99, 0
    v_mov_b32 v100, 0
    v_mov_b32 v101, 0
    v_mov_b32 v102, 0
    v_mov_b32 v103, 0
    v_mov_b32 v104, 0
    v_mov_b32 v105, 0
    v_mov_b32 v106, 0
    v_mov_b32 v107, 0
    v_mov_b32 v108, 0
    v_mov_b32 v109, 0
    v_mov_b32 v110, 0
    v_mov_b32 v111, 0
    v_mov_b32 v160, 0xff7fffff
    v_mov_b32 v164, 0xff7fffff
    v_mov_b32 v168, 0xff7fffff
    s_add_u32 s39, s40, 81920
    s_sub_u32 s38, s39, 32768
    s_mov_b32 s22, 262144
    v_add_u32 v176, s38, v176
    v_add_u32 v177, s38, v177
    v_add_u32 v178, s38, v178
    v_add_u32 v179, s38, v179
    v_add_u32 v180, s38, v180
    v_add_u32 v181, s38, v181
    v_add_u32 v182, s38, v182
    v_add_u32 v183, s38, v183
    s_mov_b32 s28, 0
FB_LOOP:
    s_waitcnt lgkmcnt(0)
    s_add_u32 m0, s39, 0
    s_add_u32 s38, s28, 0
    buffer_load_dwordx4 v186, s[16:19], s38 offen offset:0 nt lds
    buffer_load_dwordx4 v187, s[16:19], s38 offen offset:1024 nt lds
    buffer_load_dwordx4 v186, s[16:19], s38 offen offset:2048 nt lds
    buffer_load_dwordx4 v187, s[16:19], s38 offen offset:3072 nt lds
    s_add_u32 m0, s39, 4096
    s_add_u32 s38, s28, 4096
    buffer_load_dwordx4 v186, s[16:19], s38 offen offset:0 nt lds
    buffer_load_dwordx4 v187, s[16:19], s38 offen offset:1024 nt lds
    buffer_load_dwordx4 v186, s[16:19], s38 offen offset:2048 nt lds
    buffer_load_dwordx4 v187, s[16:19], s38 offen offset:3072 nt lds
    s_waitcnt vmcnt(0)
    ds_read_b128 a[48:51], v200 offset:0
    ds_read_b128 a[52:55], v201 offset:0
    ds_read_b128 a[56:59], v202 offset:0
    ds_read_b128 a[60:63], v203 offset:0
    ds_read_b128 a[64:67], v200 offset:4096
    ds_read_b128 a[68:71], v201 offset:4096
    ds_read_b128 a[72:75], v202 offset:4096
    ds_read_b128 a[76:79], v203 offset:4096
    s_waitcnt lgkmcnt(0)
    s_add_u32 m0, s39, 0
    s_add_u32 s38, s28, 0
    buffer_load_dwordx4 v186, s[20:23], s38 offen offset:0 nt lds
    buffer_load_dwordx4 v187, s[20:23], s38 offen offset:1024 nt lds
    buffer_load_dwordx4 v186, s[20:23], s38 offen offset:2048 nt lds
    buffer_load_dwordx4 v187, s[20:23], s38 offen offset:3072 nt lds
    s_add_u32 m0, s39, 4096
    s_add_u32 s38, s28, 4096
    buffer_load_dwordx4 v186, s[20:23], s38 offen offset:0 nt lds
    buffer_load_dwordx4 v187, s[20:23], s38 offen offset:1024 nt lds
    buffer_load_dwordx4 v186, s[20:23], s38 offen offset:2048 nt lds
    buffer_load_dwordx4 v187, s[20:23], s38 offen offset:3072 nt lds
    v_mfma_f32_16x16x32_bf16 v[112:115], a[48:51], a[0:3], 0
    v_mfma_f32_16x16x32_bf16 v[112:115], a[52:55], a[4:7], v[112:115]
    v_mfma_f32_16x16x32_bf16 v[112:115], a[56:59], a[8:11], v[112:115]
    v_mfma_f32_16x16x32_bf16 v[112:115], a[60:63], a[12:15], v[112:115]
    v_mfma_f32_16x16x32_bf16 v[116:119], a[64:67], a[0:3], 0
    v_mfma_f32_16x16x32_bf16 v[116:119], a[68:71], a[4:7], v[116:119]
    v_mfma_f32_16x16x32_bf16 v[116:119], a[72:75], a[8:11], v[116:119]
    v_mfma_f32_16x16x32_bf16 v[116:119], a[76:79], a[12:15], v[116:119]
    v_mfma_f32_16x16x32_bf16 v[128:131], a[48:51], a[16:19], 0
    v_mfma_f32_16x16x32_bf16 v[128:131], a[52:55], a[20:23], v[128:131]
    v_mfma_f32_16x16x32_bf16 v[128:131], a[56:59], a[24:27], v[128:131]
    v_mfma_f32_16x16x32_bf16 v[128:131], a[60:63], a[28:31], v[128:131]
    v_mfma_f32_16x16x32_bf16 v[132:135], a[64:67], a[16:19], 0
    v_mfma_f32_16x16x32_bf16 v[132:135], a[68:71], a[20:23], v[132:135]
    v_mfma_f32_16x16x32_bf16 v[132:135], a[72:75], a[24:27], v[132:135]
    v_mfma_f32_16x16x32_bf16 v[132:135], a[76:79], a[28:31], v[132:135]
    v_mfma_f32_16x16x32_bf16 v[144:147], a[48:51], a[32:35], 0
    v_mfma_f32_16x16x32_bf16 v[144:147], a[52:55], a[36:39], v[144:147]
    v_mfma_f32_16x16x32_bf16 v[144:147], a[56:59], a[40:43], v[144:147]
    v_mfma_f32_16x16x32_bf16 v[144:147], a[60:63], a[44:47], v[144:147]
    v_mfma_f32_16x16x32_bf16 v[148:151], a[64:67], a[32:35], 0
    v_mfma_f32_16x16x32_bf16 v[148:151], a[68:71], a[36:39], v[148:151]
    v_mfma_f32_16x16x32_bf16 v[148:151], a[72:75], a[40:43], v[148:151]
    v_mfma_f32_16x16x32_bf16 v[148:151], a[76:79], a[44:47], v[148:151]
    v_max3_f32 v204, v112, v113, v160
    v_max3_f32 v204, v114, v115, v204
    v_max3_f32 v204, v116, v117, v204
    v_max3_f32 v204, v118, v119, v204
    v_mov_b32 v205, v204
    s_nop 1
    v_permlane32_swap_b32 v204, v205
    v_max_f32 v204, v205, v204
    v_mov_b32 v205, v204
    s_nop 1
    v_permlane16_swap_b32 v204, v205
    v_max_f32 v204, v205, v204
    v_sub_f32 v205, v160, v204
    v_exp_f32 v205, v205
    v_mov_b32 v160, v204
    v_sub_f32 v112, v112, v204
    v_sub_f32 v113, v113, v204
    v_sub_f32 v114, v114, v204
    v_sub_f32 v115, v115, v204
    v_sub_f32 v116, v116, v204
    v_sub_f32 v117, v117, v204
    v_sub_f32 v118, v118, v204
    v_sub_f32 v119, v119, v204
    v_exp_f32 v112, v112
    v_exp_f32 v113, v113
    v_exp_f32 v114, v114
    v_cvt_pk_bf16_f32 v112, v112, v113
    v_exp_f32 v115, v115
    v_exp_f32 v116, v116
    v_cvt_pk_bf16_f32 v113, v114, v115
    v_exp_f32 v117, v117
    v_exp_f32 v118, v118
    v_cvt_pk_bf16_f32 v114, v116, v117
    v_exp_f32 v119, v119
    s_nop 0
    v_cvt_pk_bf16_f32 v115, v118, v119
    v_mul_f32 v100, v205, v100
    v_mul_f32 v101, v205, v101
    v_mul_f32 v102, v205, v102
    v_mul_f32 v103, v205, v103
    v_mul_f32 v4, v205, v4
    v_mul_f32 v5, v205, v5
    v_mul_f32 v6, v205, v6
    v_mul_f32 v7, v205, v7
    v_mul_f32 v16, v205, v16
    v_mul_f32 v17, v205, v17
    v_mul_f32 v18, v205, v18
    v_mul_f32 v19, v205, v19
    v_mul_f32 v28, v205, v28
    v_mul_f32 v29, v205, v29
    v_mul_f32 v30, v205, v30
    v_mul_f32 v31, v205, v31
    v_mul_f32 v40, v205, v40
    v_mul_f32 v41, v205, v41
    v_mul_f32 v42, v205, v42
    v_mul_f32 v43, v205, v43
    v_mul_f32 v52, v205, v52
    v_mul_f32 v53, v205, v53
    v_mul_f32 v54, v205, v54
    v_mul_f32 v55, v205, v55
    v_mul_f32 v64, v205, v64
    v_mul_f32 v65, v205, v65
    v_mul_f32 v66, v205, v66
    v_mul_f32 v67, v205, v67
    v_mul_f32 v76, v205, v76
    v_mul_f32 v77, v205, v77
    v_mul_f32 v78, v205, v78
    v_mul_f32 v79, v205, v79
    v_mul_f32 v88, v205, v88
    v_mul_f32 v89, v205, v89
    v_mul_f32 v90, v205, v90
    v_mul_f32 v91, v205, v91
    v_max3_f32 v204, v128, v129, v164
    v_max3_f32 v204, v130, v131, v204
    v_max3_f32 v204, v132, v133, v204
    v_max3_f32 v204, v134, v135, v204
    v_mov_b32 v205, v204
    s_nop 1
    v_permlane32_swap_b32 v204, v205
    v_max_f32 v204, v205, v204
    v_mov_b32 v205, v204
    s_nop 1
    v_permlane16_swap_b32 v204, v205
    v_max_f32 v204, v205, v204
    v_sub_f32 v205, v164, v204
    v_exp_f32 v205, v205
    v_mov_b32 v164, v204
    v_sub_f32 v128, v128, v204
    v_sub_f32 v129, v129, v204
    v_sub_f32 v130, v130, v204
    v_sub_f32 v131, v131, v204
    v_sub_f32 v132, v132, v204
    v_sub_f32 v133, v133, v204
    v_sub_f32 v134, v134, v204
    v_sub_f32 v135, v135, v204
    v_exp_f32 v128, v128
    v_exp_f32 v129, v129
    v_exp_f32 v130, v130
    v_cvt_pk_bf16_f32 v128, v128, v129
    v_exp_f32 v131, v131
    v_exp_f32 v132, v132
    v_cvt_pk_bf16_f32 v129, v130, v131
    v_exp_f32 v133, v133
    v_exp_f32 v134, v134
    v_cvt_pk_bf16_f32 v130, v132, v133
    v_exp_f32 v135, v135
    s_nop 0
    v_cvt_pk_bf16_f32 v131, v134, v135
    v_mul_f32 v104, v205, v104
    v_mul_f32 v105, v205, v105
    v_mul_f32 v106, v205, v106
    v_mul_f32 v107, v205, v107
    v_mul_f32 v8, v205, v8
    v_mul_f32 v9, v205, v9
    v_mul_f32 v10, v205, v10
    v_mul_f32 v11, v205, v11
    v_mul_f32 v20, v205, v20
    v_mul_f32 v21, v205, v21
    v_mul_f32 v22, v205, v22
    v_mul_f32 v23, v205, v23
    v_mul_f32 v32, v205, v32
    v_mul_f32 v33, v205, v33
    v_mul_f32 v34, v205, v34
    v_mul_f32 v35, v205, v35
    v_mul_f32 v44, v205, v44
    v_mul_f32 v45, v205, v45
    v_mul_f32 v46, v205, v46
    v_mul_f32 v47, v205, v47
    v_mul_f32 v56, v205, v56
    v_mul_f32 v57, v205, v57
    v_mul_f32 v58, v205, v58
    v_mul_f32 v59, v205, v59
    v_mul_f32 v68, v205, v68
    v_mul_f32 v69, v205, v69
    v_mul_f32 v70, v205, v70
    v_mul_f32 v71, v205, v71
    v_mul_f32 v80, v205, v80
    v_mul_f32 v81, v205, v81
    v_mul_f32 v82, v205, v82
    v_mul_f32 v83, v205, v83
    v_mul_f32 v92, v205, v92
    v_mul_f32 v93, v205, v93
    v_mul_f32 v94, v205, v94
    v_mul_f32 v95, v205, v95
    v_max3_f32 v204, v144, v145, v168
    v_max3_f32 v204, v146, v147, v204
    v_max3_f32 v204, v148, v149, v204
    v_max3_f32 v204, v150, v151, v204
    v_mov_b32 v205, v204
    s_nop 1
    v_permlane32_swap_b32 v204, v205
    v_max_f32 v204, v205, v204
    v_mov_b32 v205, v204
    s_nop 1
    v_permlane16_swap_b32 v204, v205
    v_max_f32 v204, v205, v204
    v_sub_f32 v205, v168, v204
    v_exp_f32 v205, v205
    v_mov_b32 v168, v204
    v_sub_f32 v144, v144, v204
    v_sub_f32 v145, v145, v204
    v_sub_f32 v146, v146, v204
    v_sub_f32 v147, v147, v204
    v_sub_f32 v148, v148, v204
    v_sub_f32 v149, v149, v204
    v_sub_f32 v150, v150, v204
    v_sub_f32 v151, v151, v204
    v_exp_f32 v144, v144
    v_exp_f32 v145, v145
    v_exp_f32 v146, v146
    v_cvt_pk_bf16_f32 v144, v144, v145
    v_exp_f32 v147, v147
    v_exp_f32 v148, v148
    v_cvt_pk_bf16_f32 v145, v146, v147
    v_exp_f32 v149, v149
    v_exp_f32 v150, v150
    v_cvt_pk_bf16_f32 v146, v148, v149
    v_exp_f32 v151, v151
    s_nop 0
    v_cvt_pk_bf16_f32 v147, v150, v151
    v_mul_f32 v108, v205, v108
    v_mul_f32 v109, v205, v109
    v_mul_f32 v110, v205, v110
    v_mul_f32 v111, v205, v111
    v_mul_f32 v12, v205, v12
    v_mul_f32 v13, v205, v13
    v_mul_f32 v14, v205, v14
    v_mul_f32 v15, v205, v15
    v_mul_f32 v24, v205, v24
    v_mul_f32 v25, v205, v25
    v_mul_f32 v26, v205, v26
    v_mul_f32 v27, v205, v27
    v_mul_f32 v36, v205, v36
    v_mul_f32 v37, v205, v37
    v_mul_f32 v38, v205, v38
    v_mul_f32 v39, v205, v39
    v_mul_f32 v48, v205, v48
    v_mul_f32 v49, v205, v49
    v_mul_f32 v50, v205, v50
    v_mul_f32 v51, v205, v51
    v_mul_f32 v60, v205, v60
    v_mul_f32 v61, v205, v61
    v_mul_f32 v62, v205, v62
    v_mul_f32 v63, v205, v63
    v_mul_f32 v72, v205, v72
    v_mul_f32 v73, v205, v73
    v_mul_f32 v74, v205, v74
    v_mul_f32 v75, v205, v75
    v_mul_f32 v84, v205, v84
    v_mul_f32 v85, v205, v85
    v_mul_f32 v86, v205, v86
    v_mul_f32 v87, v205, v87
    v_mul_f32 v96, v205, v96
    v_mul_f32 v97, v205, v97
    v_mul_f32 v98, v205, v98
    v_mul_f32 v99, v205, v99
    s_waitcnt vmcnt(0)
    ds_read_b64_tr_b16 a[112:113], v176 offset:0
    ds_read_b64_tr_b16 a[114:115], v176 offset:4096
    ds_read_b64_tr_b16 a[120:121], v177 offset:0
    ds_read_b64_tr_b16 a[122:123], v177 offset:4096
    ds_read_b64_tr_b16 a[128:129], v178 offset:0
    ds_read_b64_tr_b16 a[130:131], v178 offset:4096
    ds_read_b64_tr_b16 a[136:137], v179 offset:0
    ds_read_b64_tr_b16 a[138:139], v179 offset:4096
    ds_read_b64_tr_b16 a[144:145], v180 offset:0
    ds_read_b64_tr_b16 a[146:147], v180 offset:4096
    ds_read_b64_tr_b16 a[152:153], v181 offset:0
    ds_read_b64_tr_b16 a[154:155], v181 offset:4096
    ds_read_b64_tr_b16 a[160:161], v182 offset:0
    ds_read_b64_tr_b16 a[162:163], v182 offset:4096
    ds_read_b64_tr_b16 a[168:169], v183 offset:0
    ds_read_b64_tr_b16 a[170:171], v183 offset:4096
    v_mfma_f32_16x16x32_bf16 v[100:103], a[176:179], v[112:115], v[100:103]
    s_waitcnt lgkmcnt(14)
    v_mfma_f32_16x16x32_bf16 v[4:7], a[112:115], v[112:115], v[4:7]
    s_waitcnt lgkmcnt(12)
    v_mfma_f32_16x16x32_bf16 v[16:19], a[120:123], v[112:115], v[16:19]
    s_waitcnt lgkmcnt(10)
    v_mfma_f32_16x16x32_bf16 v[28:31], a[128:131], v[112:115], v[28:31]
    s_waitcnt lgkmcnt(8)
    v_mfma_f32_16x16x32_bf16 v[40:43], a[136:139], v[112:115], v[40:43]
    s_waitcnt lgkmcnt(6)
    v_mfma_f32_16x16x32_bf16 v[52:55], a[144:147], v[112:115], v[52:55]
    s_waitcnt lgkmcnt(4)
    v_mfma_f32_16x16x32_bf16 v[64:67], a[152:155], v[112:115], v[64:67]
    s_waitcnt lgkmcnt(2)
    v_mfma_f32_16x16x32_bf16 v[76:79], a[160:163], v[112:115], v[76:79]
    s_waitcnt lgkmcnt(0)
    v_mfma_f32_16x16x32_bf16 v[88:91], a[168:171], v[112:115], v[88:91]
    v_mfma_f32_16x16x32_bf16 v[104:107], a[176:179], v[128:131], v[104:107]
    v_mfma_f32_16x16x32_bf16 v[8:11], a[112:115], v[128:131], v[8:11]
    v_mfma_f32_16x16x32_bf16 v[20:23], a[120:123], v[128:131], v[20:23]
    v_mfma_f32_16x16x32_bf16 v[32:35], a[128:131], v[128:131], v[32:35]
    v_mfma_f32_16x16x32_bf16 v[44:47], a[136:139], v[128:131], v[44:47]
    v_mfma_f32_16x16x32_bf16 v[56:59], a[144:147], v[128:131], v[56:59]
    v_mfma_f32_16x16x32_bf16 v[68:71], a[152:155], v[128:131], v[68:71]
    v_mfma_f32_16x16x32_bf16 v[80:83], a[160:163], v[128:131], v[80:83]
    v_mfma_f32_16x16x32_bf16 v[92:95], a[168:171], v[128:131], v[92:95]
    v_mfma_f32_16x16x32_bf16 v[108:111], a[176:179], v[144:147], v[108:111]
    v_mfma_f32_16x16x32_bf16 v[12:15], a[112:115], v[144:147], v[12:15]
    v_mfma_f32_16x16x32_bf16 v[24:27], a[120:123], v[144:147], v[24:27]
    v_mfma_f32_16x16x32_bf16 v[36:39], a[128:131], v[144:147], v[36:39]
    v_mfma_f32_16x16x32_bf16 v[48:51], a[136:139], v[144:147], v[48:51]
    v_mfma_f32_16x16x32_bf16 v[60:63], a[144:147], v[144:147], v[60:63]
    v_mfma_f32_16x16x32_bf16 v[72:75], a[152:155], v[144:147], v[72:75]
    v_mfma_f32_16x16x32_bf16 v[84:87], a[160:163], v[144:147], v[84:87]
    v_mfma_f32_16x16x32_bf16 v[96:99], a[168:171], v[144:147], v[96:99]
    s_add_u32 s28, s28, 8192
    s_cmp_lt_u32 s28, 262144
    s_cbranch_scc1 FB_LOOP
    s_nop 7
    v_rcp_f32 v160, v100
    v_rcp_f32 v161, v101
    s_nop 0
    v_pk_mul_f32 v[4:5], v[4:5], v[160:161]
    v_pk_mul_f32 v[6:7], v[6:7], v[160:161]
    v_cvt_pk_bf16_f32 v4, v4, v5
    v_cvt_pk_bf16_f32 v5, v6, v7
    ds_write_b64 v188, v[4:5] offset:0
    v_pk_mul_f32 v[16:17], v[16:17], v[160:161]
    v_pk_mul_f32 v[18:19], v[18:19], v[160:161]
    v_cvt_pk_bf16_f32 v16, v16, v17
    v_cvt_pk_bf16_f32 v17, v18, v19
    ds_write_b64 v189, v[16:17] offset:0
    v_pk_mul_f32 v[28:29], v[28:29], v[160:161]
    v_pk_mul_f32 v[30:31], v[30:31], v[160:161]
    v_cvt_pk_bf16_f32 v28, v28, v29
    v_cvt_pk_bf16_f32 v29, v30, v31
    ds_write_b64 v190, v[28:29] offset:0
    v_pk_mul_f32 v[40:41], v[40:41], v[160:161]
    v_pk_mul_f32 v[42:43], v[42:43], v[160:161]
    v_cvt_pk_bf16_f32 v40, v40, v41
    v_cvt_pk_bf16_f32 v41, v42, v43
    ds_write_b64 v191, v[40:41] offset:0
    v_pk_mul_f32 v[52:53], v[52:53], v[160:161]
    v_pk_mul_f32 v[54:55], v[54:55], v[160:161]
    v_cvt_pk_bf16_f32 v52, v52, v53
    v_cvt_pk_bf16_f32 v53, v54, v55
    ds_write_b64 v192, v[52:53] offset:0
    v_pk_mul_f32 v[64:65], v[64:65], v[160:161]
    v_pk_mul_f32 v[66:67], v[66:67], v[160:161]
    v_cvt_pk_bf16_f32 v64, v64, v65
    v_cvt_pk_bf16_f32 v65, v66, v67
    ds_write_b64 v193, v[64:65] offset:0
    v_pk_mul_f32 v[76:77], v[76:77], v[160:161]
    v_pk_mul_f32 v[78:79], v[78:79], v[160:161]
    v_cvt_pk_bf16_f32 v76, v76, v77
    v_cvt_pk_bf16_f32 v77, v78, v79
    ds_write_b64 v194, v[76:77] offset:0
    v_pk_mul_f32 v[88:89], v[88:89], v[160:161]
    v_pk_mul_f32 v[90:91], v[90:91], v[160:161]
    v_cvt_pk_bf16_f32 v88, v88, v89
    v_cvt_pk_bf16_f32 v89, v90, v91
    ds_write_b64 v195, v[88:89] offset:0
    ds_read_b128 v[112:115], v196 offset:0
    ds_read_b128 v[116:119], v197 offset:0
    ds_read_b128 v[120:123], v198 offset:0
    ds_read_b128 v[124:127], v199 offset:0
    s_waitcnt lgkmcnt(3)
    buffer_store_dwordx4 v[112:115], v184, s[24:27], s40 offen offset:0 nt
    s_waitcnt lgkmcnt(2)
    buffer_store_dwordx4 v[116:119], v184, s[24:27], s40 offen offset:1024 nt
    s_waitcnt lgkmcnt(1)
    buffer_store_dwordx4 v[120:123], v184, s[24:27], s40 offen offset:2048 nt
    s_waitcnt lgkmcnt(0)
    buffer_store_dwordx4 v[124:127], v184, s[24:27], s40 offen offset:3072 nt
    v_rcp_f32 v164, v104
    v_rcp_f32 v165, v105
    s_nop 0
    v_pk_mul_f32 v[8:9], v[8:9], v[164:165]
    v_pk_mul_f32 v[10:11], v[10:11], v[164:165]
    v_cvt_pk_bf16_f32 v8, v8, v9
    v_cvt_pk_bf16_f32 v9, v10, v11
    ds_write_b64 v188, v[8:9] offset:4096
    v_pk_mul_f32 v[20:21], v[20:21], v[164:165]
    v_pk_mul_f32 v[22:23], v[22:23], v[164:165]
    v_cvt_pk_bf16_f32 v20, v20, v21
    v_cvt_pk_bf16_f32 v21, v22, v23
    ds_write_b64 v189, v[20:21] offset:4096
    v_pk_mul_f32 v[32:33], v[32:33], v[164:165]
    v_pk_mul_f32 v[34:35], v[34:35], v[164:165]
    v_cvt_pk_bf16_f32 v32, v32, v33
    v_cvt_pk_bf16_f32 v33, v34, v35
    ds_write_b64 v190, v[32:33] offset:4096
    v_pk_mul_f32 v[44:45], v[44:45], v[164:165]
    v_pk_mul_f32 v[46:47], v[46:47], v[164:165]
    v_cvt_pk_bf16_f32 v44, v44, v45
    v_cvt_pk_bf16_f32 v45, v46, v47
    ds_write_b64 v191, v[44:45] offset:4096
    v_pk_mul_f32 v[56:57], v[56:57], v[164:165]
    v_pk_mul_f32 v[58:59], v[58:59], v[164:165]
    v_cvt_pk_bf16_f32 v56, v56, v57
    v_cvt_pk_bf16_f32 v57, v58, v59
    ds_write_b64 v192, v[56:57] offset:4096
    v_pk_mul_f32 v[68:69], v[68:69], v[164:165]
    v_pk_mul_f32 v[70:71], v[70:71], v[164:165]
    v_cvt_pk_bf16_f32 v68, v68, v69
    v_cvt_pk_bf16_f32 v69, v70, v71
    ds_write_b64 v193, v[68:69] offset:4096
    v_pk_mul_f32 v[80:81], v[80:81], v[164:165]
    v_pk_mul_f32 v[82:83], v[82:83], v[164:165]
    v_cvt_pk_bf16_f32 v80, v80, v81
    v_cvt_pk_bf16_f32 v81, v82, v83
    ds_write_b64 v194, v[80:81] offset:4096
    v_pk_mul_f32 v[92:93], v[92:93], v[164:165]
    v_pk_mul_f32 v[94:95], v[94:95], v[164:165]
    v_cvt_pk_bf16_f32 v92, v92, v93
    v_cvt_pk_bf16_f32 v93, v94, v95
    ds_write_b64 v195, v[92:93] offset:4096
    ds_read_b128 v[128:131], v196 offset:4096
    ds_read_b128 v[132:135], v197 offset:4096
    ds_read_b128 v[136:139], v198 offset:4096
    ds_read_b128 v[140:143], v199 offset:4096
    s_waitcnt lgkmcnt(3)
    buffer_store_dwordx4 v[128:131], v184, s[24:27], s41 offen offset:0 nt
    s_waitcnt lgkmcnt(2)
    buffer_store_dwordx4 v[132:135], v184, s[24:27], s41 offen offset:1024 nt
    s_waitcnt lgkmcnt(1)
    buffer_store_dwordx4 v[136:139], v184, s[24:27], s41 offen offset:2048 nt
    s_waitcnt lgkmcnt(0)
    buffer_store_dwordx4 v[140:143], v184, s[24:27], s41 offen offset:3072 nt
    v_rcp_f32 v168, v108
    v_rcp_f32 v169, v109
    s_nop 0
    v_pk_mul_f32 v[12:13], v[12:13], v[168:169]
    v_pk_mul_f32 v[14:15], v[14:15], v[168:169]
    v_cvt_pk_bf16_f32 v12, v12, v13
    v_cvt_pk_bf16_f32 v13, v14, v15
    ds_write_b64 v188, v[12:13] offset:8192
    v_pk_mul_f32 v[24:25], v[24:25], v[168:169]
    v_pk_mul_f32 v[26:27], v[26:27], v[168:169]
    v_cvt_pk_bf16_f32 v24, v24, v25
    v_cvt_pk_bf16_f32 v25, v26, v27
    ds_write_b64 v189, v[24:25] offset:8192
    v_pk_mul_f32 v[36:37], v[36:37], v[168:169]
    v_pk_mul_f32 v[38:39], v[38:39], v[168:169]
    v_cvt_pk_bf16_f32 v36, v36, v37
    v_cvt_pk_bf16_f32 v37, v38, v39
    ds_write_b64 v190, v[36:37] offset:8192
    v_pk_mul_f32 v[48:49], v[48:49], v[168:169]
    v_pk_mul_f32 v[50:51], v[50:51], v[168:169]
    v_cvt_pk_bf16_f32 v48, v48, v49
    v_cvt_pk_bf16_f32 v49, v50, v51
    ds_write_b64 v191, v[48:49] offset:8192
    v_pk_mul_f32 v[60:61], v[60:61], v[168:169]
    v_pk_mul_f32 v[62:63], v[62:63], v[168:169]
    v_cvt_pk_bf16_f32 v60, v60, v61
    v_cvt_pk_bf16_f32 v61, v62, v63
    ds_write_b64 v192, v[60:61] offset:8192
    v_pk_mul_f32 v[72:73], v[72:73], v[168:169]
    v_pk_mul_f32 v[74:75], v[74:75], v[168:169]
    v_cvt_pk_bf16_f32 v72, v72, v73
    v_cvt_pk_bf16_f32 v73, v74, v75
    ds_write_b64 v193, v[72:73] offset:8192
    v_pk_mul_f32 v[84:85], v[84:85], v[168:169]
    v_pk_mul_f32 v[86:87], v[86:87], v[168:169]
    v_cvt_pk_bf16_f32 v84, v84, v85
    v_cvt_pk_bf16_f32 v85, v86, v87
    ds_write_b64 v194, v[84:85] offset:8192
    v_pk_mul_f32 v[96:97], v[96:97], v[168:169]
    v_pk_mul_f32 v[98:99], v[98:99], v[168:169]
    v_cvt_pk_bf16_f32 v96, v96, v97
    v_cvt_pk_bf16_f32 v97, v98, v99
    ds_write_b64 v195, v[96:97] offset:8192
    ds_read_b128 v[144:147], v196 offset:8192
    ds_read_b128 v[148:151], v197 offset:8192
    ds_read_b128 v[152:155], v198 offset:8192
    ds_read_b128 v[156:159], v199 offset:8192
    s_waitcnt lgkmcnt(3)
    buffer_store_dwordx4 v[144:147], v184, s[24:27], s42 offen offset:0 nt
    s_waitcnt lgkmcnt(2)
    buffer_store_dwordx4 v[148:151], v184, s[24:27], s42 offen offset:1024 nt
    s_waitcnt lgkmcnt(1)
    buffer_store_dwordx4 v[152:155], v184, s[24:27], s42 offen offset:2048 nt
    s_waitcnt lgkmcnt(0)
    buffer_store_dwordx4 v[156:159], v184, s[24:27], s42 offen offset:3072 nt
    s_endpgm
.section .rodata,"a"
.p2align 6
.amdhsa_kernel standalone__mha_softmax__near_ridge_kernel
  .amdhsa_next_free_vgpr 420
  .amdhsa_next_free_sgpr 102
  .amdhsa_accum_offset 240
  .amdhsa_group_segment_fixed_size 0
  .amdhsa_kernarg_size 48
  .amdhsa_user_sgpr_count 2
  .amdhsa_user_sgpr_kernarg_segment_ptr 1
  .amdhsa_system_sgpr_workgroup_id_x 1
.end_amdhsa_kernel
```
